```python
import torch

def _softmax(x, axis=-1):
    return torch.softmax(x, dim=axis)

def _gelu(x):
    return torch.nn.functional.gelu(x, approximate='tanh')

def _silu(x):
    return torch.nn.functional.silu(x)

def _sigmoid(x):
    return torch.sigmoid(x)

def _layernorm(x, axis=-1, eps=1e-05):
    m = x.mean(dim=axis, keepdim=True)
    v = x.var(dim=axis, keepdim=True, unbiased=False)
    return (x - m) / torch.sqrt(v + eps)

def _scatter_add(tgt, idx, src, axis=0):
    return tgt.clone().index_add_(axis, idx, src)

def _segment_sum(src, seg, n):
    out = torch.zeros((n,) + src.shape[1:], dtype=src.dtype)
    return out.index_add_(0, seg, src)

def _pad(x, pw):
    flat = tuple((v for pair in reversed(pw) for v in pair))
    return torch.nn.functional.pad(x, flat)
kernel_name = 'standalone__molecular_angular_painn__graph'

def setup_inputs():

    _w = lambda a: (lambda t: t.to(torch.bfloat16) if t.is_floating_point() else t)(torch.as_tensor(a))
    N, deg, D = (10000, 32, 128)
    n_rbf = max(0, 4)
    E = N * deg
    cutoff = 5.0
    freqs = (torch.arange(1, n_rbf + 1) * torch.pi / cutoff).to(float)
    return {'sv': _w((lambda *s: torch.randn(*s, dtype=torch.bfloat16) * 0.4)(N, 4, D) * 0.3), 'pos': _w((lambda *s: torch.randn(*s, dtype=torch.bfloat16) * 3.2)(N, 3) * 1.2), 'src': _w((lambda lo, hi, *s: torch.randint(lo, hi, s))(0, N, E).to(torch.int64)), 'dst': _w((lambda lo, hi, *s: torch.randint(lo, hi, s))(0, N, E).to(torch.int64)), 'freqs': _w(freqs), 'w_phi1': _w((lambda *s: torch.randn(*s, dtype=torch.bfloat16) * 3.2)(D, D) / D ** 0.5), 'w_phi2': _w((lambda *s: torch.randn(*s, dtype=torch.bfloat16) * 3.2)(D, 3 * D) / D ** 0.5), 'w_rbf': _w((lambda *s: torch.randn(*s, dtype=torch.bfloat16) * 3.2)(n_rbf, 3 * D) / n_rbf ** 0.5)}

def reference(sv, pos, src, dst, freqs, w_phi1, w_phi2, w_rbf):
    N, _, D = sv.shape
    E = src.shape[0]
    PI, cutoff = (3.141592653589793, 5.0)
    s, v = (sv[:, 0, :].clone(), sv[:, 1:, :].clone())
    r_vec = pos[src] - pos[dst]
    d = torch.sqrt((r_vec * r_vec).sum(-1) + 1e-08)
    r_hat = r_vec / d[:, None]
    rbf = torch.sin(d[:, None] * freqs[None, :]) / d[:, None]
    fcut = 0.5 * (torch.cos(PI * d / cutoff) + 1.0)
    fcut = torch.where(d < cutoff, fcut, 0.0 * d)
    Wf = rbf @ w_rbf * fcut[:, None]
    phi = (_silu(s @ w_phi1) @ w_phi2)[src]
    m = phi * Wf
    m_s, m_vv, m_vr = (m[:, :D].clone(), m[:, D:2 * D].clone(), m[:, 2 * D:].clone())
    ds = _segment_sum(m_s, dst, N)
    dv_e = m_vv[:, None, :] * v[src] + m_vr[:, None, :] * r_hat[:, :, None]
    dv = _segment_sum(dv_e.reshape(E, 3 * D), dst, N).reshape(N, 3, D)
    return sv + torch.concatenate([ds[:, None, :], dv], axis=1)
```

```asm
; @launch grid=(250,1,1) block=(640,1,1) lds=151552
.amdgcn_target "amdgcn-amd-amdhsa--gfx950"
.text
.globl standalone__molecular_angular_painn__graph_kernel
.type standalone__molecular_angular_painn__graph_kernel,@function
.p2align 8
standalone__molecular_angular_painn__graph_kernel:
    s_cmp_ge_u32 s2, 250
    s_cbranch_scc1 K_END
    s_load_dwordx4 s[4:7], s[0:1], 0
    s_load_dwordx4 s[8:11], s[0:1], 16
    s_load_dwordx4 s[12:15], s[0:1], 32
    s_load_dwordx2 s[16:17], s[0:1], 48
    s_load_dwordx2 s[94:95], s[0:1], 56
    s_load_dwordx4 s[96:99], s[0:1], 64
    s_load_dwordx2 s[100:101], s[0:1], 80
    v_lshrrev_b32 v1, 6, v0
    s_add_u32 s21, s2, 125
    s_sub_u32 s2, s2, 125
    s_cselect_b32 s2, s21, s2
    s_mov_b32 s21, s2
    v_readfirstlane_b32 s20, v1
    s_waitcnt lgkmcnt(0)
    s_cmp_lt_u32 s2, 125
    s_cbranch_scc1 K1_EDGE
    s_mov_b32 s24, s4
    s_mov_b32 s25, s5
    s_mov_b32 s26, 0x9c4000
    s_mov_b32 s27, 0x20000
    v_bfe_u32 v8, v0, 4, 2
    v_and_b32 v9, 15, v0
    s_sub_u32 s43, s2, 125
    s_mul_i32 s43, s43, 80
    s_cmp_lt_u32 s20, 8
    s_cbranch_scc1 K1M_G
    v_xor_b32 v7, v8, v9
    v_lshlrev_b32 v7, 4, v7
    v_lshl_add_u32 v18, v8, 10, v7
    s_sub_u32 s44, s20, 8
    s_mul_i32 s45, s44, 10240
    s_add_u32 s45, s45, 131072
    s_mul_i32 s44, s44, 40
    s_add_u32 s44, s44, s43
    s_lshl_b32 s44, s44, 10
    s_and_b32 s46, s20, 1
    s_lshl_b32 s46, s46, 7
    v_xor_b32 v18, s46, v18
    v_xor_b32 v19, 0x40, v18
    v_xor_b32 v20, 0x80, v18
    v_xor_b32 v21, 0xc0, v18
    s_mov_b32 m0, s45
    s_add_u32 s45, s45, 1024
    buffer_load_dwordx4 v18, s[24:27], s44 offen lds
    s_add_u32 s44, s44, 4096
    s_mov_b32 m0, s45
    s_add_u32 s45, s45, 1024
    buffer_load_dwordx4 v19, s[24:27], s44 offen lds
    s_add_u32 s44, s44, 4096
    s_mov_b32 m0, s45
    s_add_u32 s45, s45, 1024
    buffer_load_dwordx4 v20, s[24:27], s44 offen lds
    s_add_u32 s44, s44, 4096
    s_mov_b32 m0, s45
    s_add_u32 s45, s45, 1024
    buffer_load_dwordx4 v21, s[24:27], s44 offen lds
    s_add_u32 s44, s44, 4096
    s_mov_b32 m0, s45
    s_add_u32 s45, s45, 1024
    buffer_load_dwordx4 v18, s[24:27], s44 offen lds
    s_add_u32 s44, s44, 4096
    s_mov_b32 m0, s45
    s_add_u32 s45, s45, 1024
    buffer_load_dwordx4 v19, s[24:27], s44 offen lds
    s_add_u32 s44, s44, 4096
    s_mov_b32 m0, s45
    s_add_u32 s45, s45, 1024
    buffer_load_dwordx4 v20, s[24:27], s44 offen lds
    s_add_u32 s44, s44, 4096
    s_mov_b32 m0, s45
    s_add_u32 s45, s45, 1024
    buffer_load_dwordx4 v21, s[24:27], s44 offen lds
    s_add_u32 s44, s44, 4096
    s_mov_b32 m0, s45
    s_add_u32 s45, s45, 1024
    buffer_load_dwordx4 v18, s[24:27], s44 offen lds
    s_add_u32 s44, s44, 4096
    s_mov_b32 m0, s45
    s_add_u32 s45, s45, 1024
    buffer_load_dwordx4 v19, s[24:27], s44 offen lds
    s_add_u32 s44, s44, 4096
    v_lshrrev_b32 v28, 4, v0
    v_add_u32 v1, s43, v28
    v_lshlrev_b32 v7, 4, v9
    v_lshl_add_u32 v2, v1, 10, v7
    s_mov_b32 s51, 1280
    v_mad_u32_u24 v3, v1, s51, v7
    s_mov_b32 s51, 784
    v_mad_u32_u24 v4, v28, s51, v7
    v_add_u32 v4, 32768, v4
    v_xor_b32 v1, v28, v9
    v_and_b32 v1, 15, v1
    v_lshlrev_b32 v1, 4, v1
    v_lshl_add_u32 v1, v28, 8, v1
    v_add_u32 v16, 131072, v1
    s_mov_b32 s52, 0
    s_mov_b32 s53, 40960
    s_mov_b32 s60, 0
    s_mov_b32 s61, 51200
    s_mov_b32 s36, s100
    s_mov_b32 s37, s101
    s_mov_b32 s38, 0xc35000
    s_mov_b32 s39, 0x20000
    s_waitcnt vmcnt(0)
    s_barrier
    s_barrier
    buffer_load_dwordx4 v[22:25], v2, s[24:27], s52 offen offset:256
    buffer_load_dwordx4 v[26:29], v2, s[24:27], s52 offen offset:512
    buffer_load_dwordx4 v[30:33], v2, s[24:27], s52 offen offset:768
    buffer_load_dwordx4 v[34:37], v2, s[24:27], s53 offen offset:256
    buffer_load_dwordx4 v[38:41], v2, s[24:27], s53 offen offset:512
    buffer_load_dwordx4 v[42:45], v2, s[24:27], s53 offen offset:768
    s_barrier
    s_barrier
    s_branch K1M_B5
K1M_G:
    s_mov_b32 s28, s14
    s_mov_b32 s29, s15
    s_mov_b32 s30, 0x8000
    s_mov_b32 s31, 0x20000
    v_lshrrev_b32 v1, 1, v9
    v_xor_b32 v1, v1, v8
    v_and_b32 v7, 1, v0
    v_lshlrev_b32 v7, 4, v7
    v_lshl_or_b32 v1, v1, 5, v7
    v_lshl_add_u32 v12, v8, 8, v1
    v_xor_b32 v13, 0x80, v12
    s_lshl_b32 s40, s20, 12
    s_mov_b32 m0, s40
    v_mul_u32_u24 v7, 768, v8
    buffer_load_dwordx4 v12, s[28:31], s40 offen offset:0 lds
    buffer_load_dwordx4 v12, s[28:31], s40 offen offset:1024 lds
    buffer_load_dwordx4 v13, s[28:31], s40 offen offset:2048 lds
    buffer_load_dwordx4 v13, s[28:31], s40 offen offset:3072 lds
    s_mov_b32 s32, s16
    s_mov_b32 s33, s17
    s_mov_b32 s34, 0x18000
    s_mov_b32 s35, 0x20000
    v_xor_b32 v15, 0x80, v1
    v_add_u32 v14, v7, v1
    v_add_u32 v15, v7, v15
    s_mul_i32 s46, s20, 12288
    s_add_u32 s47, s40, 32768
    s_mov_b32 m0, s47
    s_add_u32 s48, s46, 0
    buffer_load_dwordx4 v14, s[32:35], s48 offen offset:0 lds
    s_add_u32 s48, s46, 2048
    buffer_load_dwordx4 v14, s[32:35], s48 offen offset:1024 lds
    s_add_u32 s48, s46, 4096
    buffer_load_dwordx4 v15, s[32:35], s48 offen offset:2048 lds
    s_add_u32 s48, s46, 6144
    buffer_load_dwordx4 v15, s[32:35], s48 offen offset:3072 lds
    s_add_u32 s47, s40, 65536
    s_mov_b32 m0, s47
    s_add_u32 s48, s46, 256
    buffer_load_dwordx4 v14, s[32:35], s48 offen offset:0 lds
    s_add_u32 s48, s46, 2304
    buffer_load_dwordx4 v14, s[32:35], s48 offen offset:1024 lds
    s_add_u32 s48, s46, 4352
    buffer_load_dwordx4 v15, s[32:35], s48 offen offset:2048 lds
    s_add_u32 s48, s46, 6400
    buffer_load_dwordx4 v15, s[32:35], s48 offen offset:3072 lds
    v_lshrrev_b32 v28, 4, v0
    v_add_u32 v1, s43, v28
    v_lshlrev_b32 v7, 4, v9
    v_lshl_add_u32 v2, v1, 10, v7
    s_mov_b32 s51, 1280
    v_mad_u32_u24 v3, v1, s51, v7
    s_mov_b32 s51, 784
    v_mad_u32_u24 v4, v28, s51, v7
    v_add_u32 v4, 32768, v4
    v_xor_b32 v1, v28, v9
    v_and_b32 v1, 15, v1
    v_lshlrev_b32 v1, 4, v1
    v_lshl_add_u32 v1, v28, 8, v1
    v_add_u32 v16, 131072, v1
    s_mov_b32 s52, 0
    s_mov_b32 s53, 40960
    s_mov_b32 s60, 0
    s_mov_b32 s61, 51200
    s_mov_b32 s36, s100
    s_mov_b32 s37, s101
    s_mov_b32 s38, 0xc35000
    s_mov_b32 s39, 0x20000
    v_bfe_u32 v10, v0, 2, 2
    v_and_b32 v11, 3, v0
    v_and_b32 v1, 1, v8
    v_lshl_or_b32 v7, v1, 2, v10
    v_xor_b32 v7, s20, v7
    v_lshlrev_b32 v7, 5, v7
    v_lshl_add_u32 v7, v11, 3, v7
    v_lshl_add_u32 v28, v8, 3, v10
    v_lshl_add_u32 v160, v28, 8, v7
    v_add_u32 v161, 0x10000, v160
    v_add_u32 v7, 0, v8
    v_xor_b32 v7, v7, v9
    v_lshlrev_b32 v7, 4, v7
    v_lshl_add_u32 v7, v9, 8, v7
    v_add_u32 v162, 131072, v7
    v_add_u32 v7, 4, v8
    v_xor_b32 v7, v7, v9
    v_lshlrev_b32 v7, 4, v7
    v_lshl_add_u32 v7, v9, 8, v7
    v_add_u32 v163, 131072, v7
    v_add_u32 v7, 8, v8
    v_xor_b32 v7, v7, v9
    v_lshlrev_b32 v7, 4, v7
    v_lshl_add_u32 v7, v9, 8, v7
    v_add_u32 v164, 131072, v7
    v_add_u32 v7, 12, v8
    v_xor_b32 v7, v7, v9
    v_lshlrev_b32 v7, 4, v7
    v_lshl_add_u32 v7, v9, 8, v7
    v_add_u32 v165, 131072, v7
    s_lshl_b32 s55, s20, 5
    v_lshl_add_u32 v7, v8, 3, s55
    v_mul_u32_u24 v29, 272, v9
    v_add_u32 v17, v29, v7
    v_lshl_add_u32 v6, v8, 4, v29
    v_mul_u32_u24 v29, 784, v9
    v_add_u32 v29, 32768, v29
    v_add_u32 v5, v29, v7
    s_mov_b32 s58, 0xbfb8aa3b
    s_waitcnt vmcnt(8)
    s_barrier
    ds_read_b64_tr_b16 v[34:35], v160 offset:0
    ds_read_b64_tr_b16 v[36:37], v160 offset:1024
    ds_read_b64_tr_b16 v[38:39], v160 offset:8192
    ds_read_b64_tr_b16 v[40:41], v160 offset:9216
    ds_read_b64_tr_b16 v[42:43], v160 offset:16384
    ds_read_b64_tr_b16 v[44:45], v160 offset:17408
    ds_read_b64_tr_b16 v[46:47], v160 offset:24576
    ds_read_b64_tr_b16 v[48:49], v160 offset:25600
    ds_read_b128 v[98:101], v162 offset:0
    ds_read_b128 v[102:105], v163 offset:0
    ds_read_b128 v[106:109], v164 offset:0
    ds_read_b128 v[110:113], v165 offset:0
    s_add_u32 s47, s40, 98304
    s_mov_b32 m0, s47
    s_add_u32 s48, s46, 512
    buffer_load_dwordx4 v14, s[32:35], s48 offen offset:0 lds
    s_add_u32 s48, s46, 2560
    buffer_load_dwordx4 v14, s[32:35], s48 offen offset:1024 lds
    s_add_u32 s48, s46, 4608
    buffer_load_dwordx4 v15, s[32:35], s48 offen offset:2048 lds
    s_add_u32 s48, s46, 6656
    buffer_load_dwordx4 v15, s[32:35], s48 offen offset:3072 lds
    s_waitcnt lgkmcnt(4)
    s_barrier
    ds_read_b128 v[114:117], v162 offset:4096
    ds_read_b128 v[118:121], v163 offset:4096
    ds_read_b128 v[122:125], v164 offset:4096
    ds_read_b128 v[126:129], v165 offset:4096
    s_waitcnt lgkmcnt(4)
    v_mfma_f32_16x16x32_bf16 v[130:133], v[34:37], v[98:101], 0
    v_mfma_f32_16x16x32_bf16 v[130:133], v[38:41], v[102:105], v[130:133]
    v_mfma_f32_16x16x32_bf16 v[130:133], v[42:45], v[106:109], v[130:133]
    v_mfma_f32_16x16x32_bf16 v[130:133], v[46:49], v[110:113], v[130:133]
    ds_read_b128 v[98:101], v162 offset:8192
    ds_read_b128 v[102:105], v163 offset:8192
    ds_read_b128 v[106:109], v164 offset:8192
    ds_read_b128 v[110:113], v165 offset:8192
    s_waitcnt lgkmcnt(4)
    v_mfma_f32_16x16x32_bf16 v[134:137], v[34:37], v[114:117], 0
    v_mfma_f32_16x16x32_bf16 v[134:137], v[38:41], v[118:121], v[134:137]
    v_mfma_f32_16x16x32_bf16 v[134:137], v[42:45], v[122:125], v[134:137]
    v_mfma_f32_16x16x32_bf16 v[134:137], v[46:49], v[126:129], v[134:137]
    ds_read_b128 v[114:117], v162 offset:12288
    ds_read_b128 v[118:121], v163 offset:12288
    ds_read_b128 v[122:125], v164 offset:12288
    ds_read_b128 v[126:129], v165 offset:12288
    s_waitcnt lgkmcnt(4)
    v_mfma_f32_16x16x32_bf16 v[138:141], v[34:37], v[98:101], 0
    v_mfma_f32_16x16x32_bf16 v[138:141], v[38:41], v[102:105], v[138:141]
    v_mfma_f32_16x16x32_bf16 v[138:141], v[42:45], v[106:109], v[138:141]
    v_mfma_f32_16x16x32_bf16 v[138:141], v[46:49], v[110:113], v[138:141]
    ds_read_b128 v[98:101], v162 offset:16384
    ds_read_b128 v[102:105], v163 offset:16384
    ds_read_b128 v[106:109], v164 offset:16384
    ds_read_b128 v[110:113], v165 offset:16384
    s_waitcnt lgkmcnt(4)
    v_mfma_f32_16x16x32_bf16 v[142:145], v[34:37], v[114:117], 0
    v_mfma_f32_16x16x32_bf16 v[142:145], v[38:41], v[118:121], v[142:145]
    v_mfma_f32_16x16x32_bf16 v[142:145], v[42:45], v[122:125], v[142:145]
    v_mfma_f32_16x16x32_bf16 v[142:145], v[46:49], v[126:129], v[142:145]
    s_waitcnt lgkmcnt(0)
    v_mfma_f32_16x16x32_bf16 v[146:149], v[34:37], v[98:101], 0
    v_mfma_f32_16x16x32_bf16 v[146:149], v[38:41], v[102:105], v[146:149]
    v_mfma_f32_16x16x32_bf16 v[146:149], v[42:45], v[106:109], v[146:149]
    v_mfma_f32_16x16x32_bf16 v[146:149], v[46:49], v[110:113], v[146:149]
    buffer_load_dwordx4 v[22:25], v2, s[24:27], s52 offen offset:256
    buffer_load_dwordx4 v[26:29], v2, s[24:27], s52 offen offset:512
    buffer_load_dwordx4 v[30:33], v2, s[24:27], s52 offen offset:768
    buffer_load_dwordx4 v[34:37], v2, s[24:27], s53 offen offset:256
    buffer_load_dwordx4 v[38:41], v2, s[24:27], s53 offen offset:512
    buffer_load_dwordx4 v[42:45], v2, s[24:27], s53 offen offset:768
    v_cvt_pk_bf16_f32 v153, v130, v131
    v_lshlrev_b32 v152, 16, v153
    v_and_b32 v153, 0xffff0000, v153
    v_mul_f32 v154, s58, v152
    v_mul_f32 v155, s58, v153
    v_exp_f32 v154, v154
    v_exp_f32 v155, v155
    v_add_f32 v154, 1.0, v154
    v_add_f32 v155, 1.0, v155
    v_rcp_f32 v154, v154
    v_rcp_f32 v155, v155
    v_mul_f32 v152, v152, v154
    v_mul_f32 v153, v153, v155
    v_cvt_pk_bf16_f32 v130, v152, v153
    v_cvt_pk_bf16_f32 v157, v132, v133
    v_lshlrev_b32 v156, 16, v157
    v_and_b32 v157, 0xffff0000, v157
    v_mul_f32 v158, s58, v156
    v_mul_f32 v159, s58, v157
    v_exp_f32 v158, v158
    v_exp_f32 v159, v159
    v_add_f32 v158, 1.0, v158
    v_add_f32 v159, 1.0, v159
    v_rcp_f32 v158, v158
    v_rcp_f32 v159, v159
    v_mul_f32 v156, v156, v158
    v_mul_f32 v157, v157, v159
    v_cvt_pk_bf16_f32 v131, v156, v157
    ds_write_b64 v17, v[130:131] offset:0
    v_cvt_pk_bf16_f32 v153, v134, v135
    v_lshlrev_b32 v152, 16, v153
    v_and_b32 v153, 0xffff0000, v153
    v_mul_f32 v154, s58, v152
    v_mul_f32 v155, s58, v153
    v_exp_f32 v154, v154
    v_exp_f32 v155, v155
    v_add_f32 v154, 1.0, v154
    v_add_f32 v155, 1.0, v155
    v_rcp_f32 v154, v154
    v_rcp_f32 v155, v155
    v_mul_f32 v152, v152, v154
    v_mul_f32 v153, v153, v155
    v_cvt_pk_bf16_f32 v134, v152, v153
    v_cvt_pk_bf16_f32 v157, v136, v137
    v_lshlrev_b32 v156, 16, v157
    v_and_b32 v157, 0xffff0000, v157
    v_mul_f32 v158, s58, v156
    v_mul_f32 v159, s58, v157
    v_exp_f32 v158, v158
    v_exp_f32 v159, v159
    v_add_f32 v158, 1.0, v158
    v_add_f32 v159, 1.0, v159
    v_rcp_f32 v158, v158
    v_rcp_f32 v159, v159
    v_mul_f32 v156, v156, v158
    v_mul_f32 v157, v157, v159
    v_cvt_pk_bf16_f32 v135, v156, v157
    ds_write_b64 v17, v[134:135] offset:4352
    v_cvt_pk_bf16_f32 v153, v138, v139
    v_lshlrev_b32 v152, 16, v153
    v_and_b32 v153, 0xffff0000, v153
    v_mul_f32 v154, s58, v152
    v_mul_f32 v155, s58, v153
    v_exp_f32 v154, v154
    v_exp_f32 v155, v155
    v_add_f32 v154, 1.0, v154
    v_add_f32 v155, 1.0, v155
    v_rcp_f32 v154, v154
    v_rcp_f32 v155, v155
    v_mul_f32 v152, v152, v154
    v_mul_f32 v153, v153, v155
    v_cvt_pk_bf16_f32 v138, v152, v153
    v_cvt_pk_bf16_f32 v157, v140, v141
    v_lshlrev_b32 v156, 16, v157
    v_and_b32 v157, 0xffff0000, v157
    v_mul_f32 v158, s58, v156
    v_mul_f32 v159, s58, v157
    v_exp_f32 v158, v158
    v_exp_f32 v159, v159
    v_add_f32 v158, 1.0, v158
    v_add_f32 v159, 1.0, v159
    v_rcp_f32 v158, v158
    v_rcp_f32 v159, v159
    v_mul_f32 v156, v156, v158
    v_mul_f32 v157, v157, v159
    v_cvt_pk_bf16_f32 v139, v156, v157
    ds_write_b64 v17, v[138:139] offset:8704
    v_cvt_pk_bf16_f32 v153, v142, v143
    v_lshlrev_b32 v152, 16, v153
    v_and_b32 v153, 0xffff0000, v153
    v_mul_f32 v154, s58, v152
    v_mul_f32 v155, s58, v153
    v_exp_f32 v154, v154
    v_exp_f32 v155, v155
    v_add_f32 v154, 1.0, v154
    v_add_f32 v155, 1.0, v155
    v_rcp_f32 v154, v154
    v_rcp_f32 v155, v155
    v_mul_f32 v152, v152, v154
    v_mul_f32 v153, v153, v155
    v_cvt_pk_bf16_f32 v142, v152, v153
    v_cvt_pk_bf16_f32 v157, v144, v145
    v_lshlrev_b32 v156, 16, v157
    v_and_b32 v157, 0xffff0000, v157
    v_mul_f32 v158, s58, v156
    v_mul_f32 v159, s58, v157
    v_exp_f32 v158, v158
    v_exp_f32 v159, v159
    v_add_f32 v158, 1.0, v158
    v_add_f32 v159, 1.0, v159
    v_rcp_f32 v158, v158
    v_rcp_f32 v159, v159
    v_mul_f32 v156, v156, v158
    v_mul_f32 v157, v157, v159
    v_cvt_pk_bf16_f32 v143, v156, v157
    ds_write_b64 v17, v[142:143] offset:13056
    v_cvt_pk_bf16_f32 v153, v146, v147
    v_lshlrev_b32 v152, 16, v153
    v_and_b32 v153, 0xffff0000, v153
    v_mul_f32 v154, s58, v152
    v_mul_f32 v155, s58, v153
    v_exp_f32 v154, v154
    v_exp_f32 v155, v155
    v_add_f32 v154, 1.0, v154
    v_add_f32 v155, 1.0, v155
    v_rcp_f32 v154, v154
    v_rcp_f32 v155, v155
    v_mul_f32 v152, v152, v154
    v_mul_f32 v153, v153, v155
    v_cvt_pk_bf16_f32 v146, v152, v153
    v_cvt_pk_bf16_f32 v157, v148, v149
    v_lshlrev_b32 v156, 16, v157
    v_and_b32 v157, 0xffff0000, v157
    v_mul_f32 v158, s58, v156
    v_mul_f32 v159, s58, v157
    v_exp_f32 v158, v158
    v_exp_f32 v159, v159
    v_add_f32 v158, 1.0, v158
    v_add_f32 v159, 1.0, v159
    v_rcp_f32 v158, v158
    v_rcp_f32 v159, v159
    v_mul_f32 v156, v156, v158
    v_mul_f32 v157, v157, v159
    v_cvt_pk_bf16_f32 v147, v156, v157
    ds_write_b64 v17, v[146:147] offset:17408
    s_waitcnt vmcnt(6) lgkmcnt(0)
    s_barrier
    ds_read_b128 v[98:101], v6 offset:0
    ds_read_b128 v[102:105], v6 offset:64
    ds_read_b128 v[106:109], v6 offset:128
    ds_read_b128 v[110:113], v6 offset:192
    s_waitcnt lgkmcnt(7)
    ds_read_b64_tr_b16 v[50:51], v160 offset:32768
    ds_read_b64_tr_b16 v[52:53], v160 offset:33792
    ds_read_b64_tr_b16 v[54:55], v160 offset:40960
    ds_read_b64_tr_b16 v[56:57], v160 offset:41984
    ds_read_b64_tr_b16 v[58:59], v160 offset:49152
    ds_read_b64_tr_b16 v[60:61], v160 offset:50176
    ds_read_b64_tr_b16 v[62:63], v160 offset:57344
    ds_read_b64_tr_b16 v[64:65], v160 offset:58368
    s_waitcnt lgkmcnt(7)
    ds_read_b64_tr_b16 v[66:67], v161 offset:0
    ds_read_b64_tr_b16 v[68:69], v161 offset:1024
    ds_read_b64_tr_b16 v[70:71], v161 offset:8192
    ds_read_b64_tr_b16 v[72:73], v161 offset:9216
    ds_read_b64_tr_b16 v[74:75], v161 offset:16384
    ds_read_b64_tr_b16 v[76:77], v161 offset:17408
    ds_read_b64_tr_b16 v[78:79], v161 offset:24576
    ds_read_b64_tr_b16 v[80:81], v161 offset:25600
    s_waitcnt lgkmcnt(7)
    ds_read_b64_tr_b16 v[82:83], v161 offset:32768
    ds_read_b64_tr_b16 v[84:85], v161 offset:33792
    ds_read_b64_tr_b16 v[86:87], v161 offset:40960
    ds_read_b64_tr_b16 v[88:89], v161 offset:41984
    ds_read_b64_tr_b16 v[90:91], v161 offset:49152
    ds_read_b64_tr_b16 v[92:93], v161 offset:50176
    ds_read_b64_tr_b16 v[94:95], v161 offset:57344
    ds_read_b64_tr_b16 v[96:97], v161 offset:58368
    ds_read_b128 v[114:117], v6 offset:4352
    ds_read_b128 v[118:121], v6 offset:4416
    ds_read_b128 v[122:125], v6 offset:4480
    ds_read_b128 v[126:129], v6 offset:4544
    s_waitcnt lgkmcnt(4)
    s_barrier
    v_mfma_f32_16x16x32_bf16 v[130:133], v[50:53], v[98:101], 0
    v_mfma_f32_16x16x32_bf16 v[134:137], v[66:69], v[98:101], 0
    v_mfma_f32_16x16x32_bf16 v[138:141], v[82:85], v[98:101], 0
    v_mfma_f32_16x16x32_bf16 v[130:133], v[54:57], v[102:105], v[130:133]
    v_mfma_f32_16x16x32_bf16 v[134:137], v[70:73], v[102:105], v[134:137]
    v_mfma_f32_16x16x32_bf16 v[138:141], v[86:89], v[102:105], v[138:141]
    v_mfma_f32_16x16x32_bf16 v[130:133], v[58:61], v[106:109], v[130:133]
    v_mfma_f32_16x16x32_bf16 v[134:137], v[74:77], v[106:109], v[134:137]
    v_mfma_f32_16x16x32_bf16 v[138:141], v[90:93], v[106:109], v[138:141]
    v_mfma_f32_16x16x32_bf16 v[130:133], v[62:65], v[110:113], v[130:133]
    v_mfma_f32_16x16x32_bf16 v[134:137], v[78:81], v[110:113], v[134:137]
    v_mfma_f32_16x16x32_bf16 v[138:141], v[94:97], v[110:113], v[138:141]
    ds_read_b128 v[98:101], v6 offset:8704
    ds_read_b128 v[102:105], v6 offset:8768
    ds_read_b128 v[106:109], v6 offset:8832
    ds_read_b128 v[110:113], v6 offset:8896
    s_waitcnt lgkmcnt(4)
    v_mfma_f32_16x16x32_bf16 v[142:145], v[50:53], v[114:117], 0
    v_mfma_f32_16x16x32_bf16 v[146:149], v[66:69], v[114:117], 0
    v_mfma_f32_16x16x32_bf16 v[150:153], v[82:85], v[114:117], 0
    v_mfma_f32_16x16x32_bf16 v[142:145], v[54:57], v[118:121], v[142:145]
    v_mfma_f32_16x16x32_bf16 v[146:149], v[70:73], v[118:121], v[146:149]
    v_mfma_f32_16x16x32_bf16 v[150:153], v[86:89], v[118:121], v[150:153]
    v_cvt_pk_bf16_f32 v130, v130, v131
    v_cvt_pk_bf16_f32 v131, v132, v133
    ds_write_b64 v5, v[130:131] offset:0
    v_mfma_f32_16x16x32_bf16 v[142:145], v[58:61], v[122:125], v[142:145]
    v_mfma_f32_16x16x32_bf16 v[146:149], v[74:77], v[122:125], v[146:149]
    v_mfma_f32_16x16x32_bf16 v[150:153], v[90:93], v[122:125], v[150:153]
    v_cvt_pk_bf16_f32 v134, v134, v135
    v_cvt_pk_bf16_f32 v135, v136, v137
    ds_write_b64 v5, v[134:135] offset:256
    v_mfma_f32_16x16x32_bf16 v[142:145], v[62:65], v[126:129], v[142:145]
    v_mfma_f32_16x16x32_bf16 v[146:149], v[78:81], v[126:129], v[146:149]
    v_mfma_f32_16x16x32_bf16 v[150:153], v[94:97], v[126:129], v[150:153]
    v_cvt_pk_bf16_f32 v138, v138, v139
    v_cvt_pk_bf16_f32 v139, v140, v141
    ds_write_b64 v5, v[138:139] offset:512
    ds_read_b128 v[114:117], v6 offset:13056
    ds_read_b128 v[118:121], v6 offset:13120
    ds_read_b128 v[122:125], v6 offset:13184
    ds_read_b128 v[126:129], v6 offset:13248
    s_waitcnt lgkmcnt(7)
    v_mfma_f32_16x16x32_bf16 v[130:133], v[50:53], v[98:101], 0
    v_mfma_f32_16x16x32_bf16 v[134:137], v[66:69], v[98:101], 0
    v_mfma_f32_16x16x32_bf16 v[138:141], v[82:85], v[98:101], 0
    v_mfma_f32_16x16x32_bf16 v[130:133], v[54:57], v[102:105], v[130:133]
    v_mfma_f32_16x16x32_bf16 v[134:137], v[70:73], v[102:105], v[134:137]
    v_mfma_f32_16x16x32_bf16 v[138:141], v[86:89], v[102:105], v[138:141]
    v_cvt_pk_bf16_f32 v142, v142, v143
    v_cvt_pk_bf16_f32 v143, v144, v145
    ds_write_b64 v5, v[142:143] offset:12544
    v_mfma_f32_16x16x32_bf16 v[130:133], v[58:61], v[106:109], v[130:133]
    v_mfma_f32_16x16x32_bf16 v[134:137], v[74:77], v[106:109], v[134:137]
    v_mfma_f32_16x16x32_bf16 v[138:141], v[90:93], v[106:109], v[138:141]
    v_cvt_pk_bf16_f32 v146, v146, v147
    v_cvt_pk_bf16_f32 v147, v148, v149
    ds_write_b64 v5, v[146:147] offset:12800
    v_mfma_f32_16x16x32_bf16 v[130:133], v[62:65], v[110:113], v[130:133]
    v_mfma_f32_16x16x32_bf16 v[134:137], v[78:81], v[110:113], v[134:137]
    v_mfma_f32_16x16x32_bf16 v[138:141], v[94:97], v[110:113], v[138:141]
    v_cvt_pk_bf16_f32 v150, v150, v151
    v_cvt_pk_bf16_f32 v151, v152, v153
    ds_write_b64 v5, v[150:151] offset:13056
    ds_read_b128 v[98:101], v6 offset:17408
    ds_read_b128 v[102:105], v6 offset:17472
    ds_read_b128 v[106:109], v6 offset:17536
    ds_read_b128 v[110:113], v6 offset:17600
    s_waitcnt lgkmcnt(7)
    v_mfma_f32_16x16x32_bf16 v[142:145], v[50:53], v[114:117], 0
    v_mfma_f32_16x16x32_bf16 v[146:149], v[66:69], v[114:117], 0
    v_mfma_f32_16x16x32_bf16 v[150:153], v[82:85], v[114:117], 0
    v_mfma_f32_16x16x32_bf16 v[142:145], v[54:57], v[118:121], v[142:145]
    v_mfma_f32_16x16x32_bf16 v[146:149], v[70:73], v[118:121], v[146:149]
    v_mfma_f32_16x16x32_bf16 v[150:153], v[86:89], v[118:121], v[150:153]
    v_cvt_pk_bf16_f32 v130, v130, v131
    v_cvt_pk_bf16_f32 v131, v132, v133
    ds_write_b64 v5, v[130:131] offset:25088
    v_mfma_f32_16x16x32_bf16 v[142:145], v[58:61], v[122:125], v[142:145]
    v_mfma_f32_16x16x32_bf16 v[146:149], v[74:77], v[122:125], v[146:149]
    v_mfma_f32_16x16x32_bf16 v[150:153], v[90:93], v[122:125], v[150:153]
    v_cvt_pk_bf16_f32 v134, v134, v135
    v_cvt_pk_bf16_f32 v135, v136, v137
    ds_write_b64 v5, v[134:135] offset:25344
    v_mfma_f32_16x16x32_bf16 v[142:145], v[62:65], v[126:129], v[142:145]
    v_mfma_f32_16x16x32_bf16 v[146:149], v[78:81], v[126:129], v[146:149]
    v_mfma_f32_16x16x32_bf16 v[150:153], v[94:97], v[126:129], v[150:153]
    v_cvt_pk_bf16_f32 v138, v138, v139
    v_cvt_pk_bf16_f32 v139, v140, v141
    ds_write_b64 v5, v[138:139] offset:25600
    s_waitcnt lgkmcnt(3)
    v_mfma_f32_16x16x32_bf16 v[130:133], v[50:53], v[98:101], 0
    v_mfma_f32_16x16x32_bf16 v[134:137], v[66:69], v[98:101], 0
    v_mfma_f32_16x16x32_bf16 v[138:141], v[82:85], v[98:101], 0
    v_mfma_f32_16x16x32_bf16 v[130:133], v[54:57], v[102:105], v[130:133]
    v_mfma_f32_16x16x32_bf16 v[134:137], v[70:73], v[102:105], v[134:137]
    v_mfma_f32_16x16x32_bf16 v[138:141], v[86:89], v[102:105], v[138:141]
    v_cvt_pk_bf16_f32 v142, v142, v143
    v_cvt_pk_bf16_f32 v143, v144, v145
    ds_write_b64 v5, v[142:143] offset:37632
    v_mfma_f32_16x16x32_bf16 v[130:133], v[58:61], v[106:109], v[130:133]
    v_mfma_f32_16x16x32_bf16 v[134:137], v[74:77], v[106:109], v[134:137]
    v_mfma_f32_16x16x32_bf16 v[138:141], v[90:93], v[106:109], v[138:141]
    v_cvt_pk_bf16_f32 v146, v146, v147
    v_cvt_pk_bf16_f32 v147, v148, v149
    ds_write_b64 v5, v[146:147] offset:37888
    v_mfma_f32_16x16x32_bf16 v[130:133], v[62:65], v[110:113], v[130:133]
    v_mfma_f32_16x16x32_bf16 v[134:137], v[78:81], v[110:113], v[134:137]
    v_mfma_f32_16x16x32_bf16 v[138:141], v[94:97], v[110:113], v[138:141]
    v_cvt_pk_bf16_f32 v150, v150, v151
    v_cvt_pk_bf16_f32 v151, v152, v153
    ds_write_b64 v5, v[150:151] offset:38144
    s_nop 2
    v_cvt_pk_bf16_f32 v130, v130, v131
    v_cvt_pk_bf16_f32 v131, v132, v133
    ds_write_b64 v5, v[130:131] offset:50176
    v_cvt_pk_bf16_f32 v134, v134, v135
    v_cvt_pk_bf16_f32 v135, v136, v137
    ds_write_b64 v5, v[134:135] offset:50432
    v_cvt_pk_bf16_f32 v138, v138, v139
    v_cvt_pk_bf16_f32 v139, v140, v141
    ds_write_b64 v5, v[138:139] offset:50688
    s_waitcnt lgkmcnt(0)
K1M_B5:
    s_barrier
    ds_read_b128 v[18:21], v16
    ds_read_b128 v[98:101], v4 offset:0
    ds_read_b128 v[102:105], v4 offset:256
    ds_read_b128 v[106:109], v4 offset:512
    ds_read_b128 v[110:113], v4 offset:31360
    ds_read_b128 v[114:117], v4 offset:31616
    ds_read_b128 v[118:121], v4 offset:31872
    s_waitcnt lgkmcnt(3)
    buffer_store_dwordx4 v[98:101], v3, s[36:39], s60 offen sc1
    buffer_store_dwordx4 v[106:109], v3, s[36:39], s60 offen offset:1024 sc1
    v_lshlrev_b32 v130, 16, v102
    v_and_b32 v131, 0xffff0000, v102
    v_lshlrev_b32 v132, 16, v103
    v_and_b32 v133, 0xffff0000, v103
    v_lshlrev_b32 v134, 16, v104
    v_and_b32 v135, 0xffff0000, v104
    v_lshlrev_b32 v136, 16, v105
    v_and_b32 v137, 0xffff0000, v105
    s_waitcnt vmcnt(7)
    v_lshlrev_b32 v138, 16, v22
    v_and_b32 v139, 0xffff0000, v22
    v_lshlrev_b32 v140, 16, v23
    v_and_b32 v141, 0xffff0000, v23
    v_lshlrev_b32 v142, 16, v24
    v_and_b32 v143, 0xffff0000, v24
    v_lshlrev_b32 v144, 16, v25
    v_and_b32 v145, 0xffff0000, v25
    v_mul_f32 v138, v138, v130
    v_mul_f32 v139, v139, v131
    v_mul_f32 v140, v140, v132
    v_mul_f32 v141, v141, v133
    v_mul_f32 v142, v142, v134
    v_mul_f32 v143, v143, v135
    v_mul_f32 v144, v144, v136
    v_mul_f32 v145, v145, v137
    v_cvt_pk_bf16_f32 v46, v138, v139
    v_cvt_pk_bf16_f32 v47, v140, v141
    v_cvt_pk_bf16_f32 v48, v142, v143
    v_cvt_pk_bf16_f32 v49, v144, v145
    buffer_store_dwordx4 v[46:49], v3, s[36:39], s60 offen offset:256 sc1
    s_waitcnt vmcnt(7)
    v_lshlrev_b32 v146, 16, v26
    v_and_b32 v147, 0xffff0000, v26
    v_lshlrev_b32 v148, 16, v27
    v_and_b32 v149, 0xffff0000, v27
    v_lshlrev_b32 v150, 16, v28
    v_and_b32 v151, 0xffff0000, v28
    v_lshlrev_b32 v152, 16, v29
    v_and_b32 v153, 0xffff0000, v29
    v_mul_f32 v146, v146, v130
    v_mul_f32 v147, v147, v131
    v_mul_f32 v148, v148, v132
    v_mul_f32 v149, v149, v133
    v_mul_f32 v150, v150, v134
    v_mul_f32 v151, v151, v135
    v_mul_f32 v152, v152, v136
    v_mul_f32 v153, v153, v137
    v_cvt_pk_bf16_f32 v164, v146, v147
    v_cvt_pk_bf16_f32 v165, v148, v149
    v_cvt_pk_bf16_f32 v166, v150, v151
    v_cvt_pk_bf16_f32 v167, v152, v153
    buffer_store_dwordx4 v[164:167], v3, s[36:39], s60 offen offset:512 sc1
    s_waitcnt vmcnt(7)
    v_lshlrev_b32 v138, 16, v30
    v_and_b32 v139, 0xffff0000, v30
    v_lshlrev_b32 v140, 16, v31
    v_and_b32 v141, 0xffff0000, v31
    v_lshlrev_b32 v142, 16, v32
    v_and_b32 v143, 0xffff0000, v32
    v_lshlrev_b32 v144, 16, v33
    v_and_b32 v145, 0xffff0000, v33
    v_mul_f32 v138, v138, v130
    v_mul_f32 v139, v139, v131
    v_mul_f32 v140, v140, v132
    v_mul_f32 v141, v141, v133
    v_mul_f32 v142, v142, v134
    v_mul_f32 v143, v143, v135
    v_mul_f32 v144, v144, v136
    v_mul_f32 v145, v145, v137
    v_cvt_pk_bf16_f32 v46, v138, v139
    v_cvt_pk_bf16_f32 v47, v140, v141
    v_cvt_pk_bf16_f32 v48, v142, v143
    v_cvt_pk_bf16_f32 v49, v144, v145
    buffer_store_dwordx4 v[46:49], v3, s[36:39], s60 offen offset:768 sc1
    s_waitcnt lgkmcnt(0)
    buffer_store_dwordx4 v[110:113], v3, s[36:39], s61 offen sc1
    buffer_store_dwordx4 v[118:121], v3, s[36:39], s61 offen offset:1024 sc1
    v_lshlrev_b32 v130, 16, v114
    v_and_b32 v131, 0xffff0000, v114
    v_lshlrev_b32 v132, 16, v115
    v_and_b32 v133, 0xffff0000, v115
    v_lshlrev_b32 v134, 16, v116
    v_and_b32 v135, 0xffff0000, v116
    v_lshlrev_b32 v136, 16, v117
    v_and_b32 v137, 0xffff0000, v117
    s_waitcnt vmcnt(9)
    v_lshlrev_b32 v138, 16, v34
    v_and_b32 v139, 0xffff0000, v34
    v_lshlrev_b32 v140, 16, v35
    v_and_b32 v141, 0xffff0000, v35
    v_lshlrev_b32 v142, 16, v36
    v_and_b32 v143, 0xffff0000, v36
    v_lshlrev_b32 v144, 16, v37
    v_and_b32 v145, 0xffff0000, v37
    v_mul_f32 v138, v138, v130
    v_mul_f32 v139, v139, v131
    v_mul_f32 v140, v140, v132
    v_mul_f32 v141, v141, v133
    v_mul_f32 v142, v142, v134
    v_mul_f32 v143, v143, v135
    v_mul_f32 v144, v144, v136
    v_mul_f32 v145, v145, v137
    v_cvt_pk_bf16_f32 v34, v138, v139
    v_cvt_pk_bf16_f32 v35, v140, v141
    v_cvt_pk_bf16_f32 v36, v142, v143
    v_cvt_pk_bf16_f32 v37, v144, v145
    buffer_store_dwordx4 v[34:37], v3, s[36:39], s61 offen offset:256 sc1
    s_waitcnt vmcnt(9)
    v_lshlrev_b32 v146, 16, v38
    v_and_b32 v147, 0xffff0000, v38
    v_lshlrev_b32 v148, 16, v39
    v_and_b32 v149, 0xffff0000, v39
    v_lshlrev_b32 v150, 16, v40
    v_and_b32 v151, 0xffff0000, v40
    v_lshlrev_b32 v152, 16, v41
    v_and_b32 v153, 0xffff0000, v41
    v_mul_f32 v146, v146, v130
    v_mul_f32 v147, v147, v131
    v_mul_f32 v148, v148, v132
    v_mul_f32 v149, v149, v133
    v_mul_f32 v150, v150, v134
    v_mul_f32 v151, v151, v135
    v_mul_f32 v152, v152, v136
    v_mul_f32 v153, v153, v137
    v_cvt_pk_bf16_f32 v38, v146, v147
    v_cvt_pk_bf16_f32 v39, v148, v149
    v_cvt_pk_bf16_f32 v40, v150, v151
    v_cvt_pk_bf16_f32 v41, v152, v153
    buffer_store_dwordx4 v[38:41], v3, s[36:39], s61 offen offset:512 sc1
    s_waitcnt vmcnt(9)
    v_lshlrev_b32 v138, 16, v42
    v_and_b32 v139, 0xffff0000, v42
    v_lshlrev_b32 v140, 16, v43
    v_and_b32 v141, 0xffff0000, v43
    v_lshlrev_b32 v142, 16, v44
    v_and_b32 v143, 0xffff0000, v44
    v_lshlrev_b32 v144, 16, v45
    v_and_b32 v145, 0xffff0000, v45
    v_mul_f32 v138, v138, v130
    v_mul_f32 v139, v139, v131
    v_mul_f32 v140, v140, v132
    v_mul_f32 v141, v141, v133
    v_mul_f32 v142, v142, v134
    v_mul_f32 v143, v143, v135
    v_mul_f32 v144, v144, v136
    v_mul_f32 v145, v145, v137
    v_cvt_pk_bf16_f32 v42, v138, v139
    v_cvt_pk_bf16_f32 v43, v140, v141
    v_cvt_pk_bf16_f32 v44, v142, v143
    v_cvt_pk_bf16_f32 v45, v144, v145
    buffer_store_dwordx4 v[42:45], v3, s[36:39], s61 offen offset:768 sc1
    s_mov_b32 s22, 4
    s_branch PHASE_B
K1_EDGE:
    s_mov_b32 s28, s8
    s_mov_b32 s29, s9
    s_mov_b32 s30, 0x138800
    s_mov_b32 s31, 0x20000
    s_mov_b32 s32, s10
    s_mov_b32 s33, s11
    s_mov_b32 s34, 0x138800
    s_mov_b32 s35, 0x20000
    s_mov_b32 s24, s6
    s_mov_b32 s25, s7
    s_mov_b32 s26, 0xea60
    s_mov_b32 s27, 0x20000
    v_and_b32 v1, 63, v0
    v_lshlrev_b32 v1, 4, v1
    v_lshlrev_b32 v2, 4, v0
    s_mul_i32 s66, s2, 10240
    buffer_load_dwordx4 v[10:13], v2, s[28:31], s66 offen
    buffer_load_dwordx4 v[16:19], v2, s[32:35], s66 offen
    s_mul_i32 s64, s20, 6144
    s_add_u32 s65, s64, 0
    s_add_u32 s68, s65, 66624
    s_mov_b32 m0, s68
    s_nop 0
    buffer_load_dwordx4 v1, s[24:27], s65 offen offset:0 lds
    buffer_load_dwordx4 v1, s[24:27], s65 offen offset:1024 lds
    buffer_load_dwordx4 v1, s[24:27], s65 offen offset:2048 lds
    buffer_load_dwordx4 v1, s[24:27], s65 offen offset:3072 lds
    s_add_u32 s65, s64, 4096
    s_add_u32 s68, s65, 66624
    s_mov_b32 m0, s68
    s_nop 0
    buffer_load_dwordx4 v1, s[24:27], s65 offen offset:0 lds
    buffer_load_dwordx4 v1, s[24:27], s65 offen offset:1024 lds
    s_add_u32 s36, s100, 0x1000000
    s_addc_u32 s37, s101, 0
    s_mov_b32 s38, 0xae2000
    s_mov_b32 s39, 0x20000
    s_load_dwordx2 s[72:73], s[12:13], 0
    v_mov_b32 v4, -1
    v_mov_b32 v5, -1
    v_mov_b32 v6, -1
    v_mov_b32 v7, -1
    v_mov_b32 v8, 0
    v_mov_b32 v9, 0
    v_lshlrev_b32 v34, 3, v0
    ds_write_b64 v34, v[8:9] offset:0
    ds_write_b32 v8, v8 offset:5120
    ds_write_b128 v2, v[4:7] offset:25664
    ds_write_b128 v2, v[4:7] offset:35904
    ds_write_b128 v2, v[4:7] offset:46144
    ds_write_b128 v2, v[4:7] offset:56384
    s_mov_b32 s52, 52429
    v_mov_b32 v8, 1
    v_mov_b32 v9, 0x200
    s_mov_b32 s69, 66624
    s_mov_b32 s70, 0x41ca0000
    s_mov_b32 s71, 0
    s_waitcnt vmcnt(0) lgkmcnt(0)
    s_barrier
    v_mad_u32_u24 v70, v10, 6, s69
    v_lshlrev_b32 v44, 3, v70
    v_and_b32 v70, -4, v70
    ds_read2_b32 v[40:41], v70 offset0:0 offset1:1
    v_mad_u32_u24 v71, v16, 6, s69
    v_lshlrev_b32 v45, 3, v71
    v_and_b32 v71, -4, v71
    ds_read2_b32 v[42:43], v71 offset0:0 offset1:1
    v_mad_u32_u24 v70, v11, 6, s69
    v_lshlrev_b32 v50, 3, v70
    v_and_b32 v70, -4, v70
    ds_read2_b32 v[46:47], v70 offset0:0 offset1:1
    v_mad_u32_u24 v71, v17, 6, s69
    v_lshlrev_b32 v51, 3, v71
    v_and_b32 v71, -4, v71
    ds_read2_b32 v[48:49], v71 offset0:0 offset1:1
    v_mad_u32_u24 v70, v12, 6, s69
    v_lshlrev_b32 v56, 3, v70
    v_and_b32 v70, -4, v70
    ds_read2_b32 v[52:53], v70 offset0:0 offset1:1
    v_mad_u32_u24 v71, v18, 6, s69
    v_lshlrev_b32 v57, 3, v71
    v_and_b32 v71, -4, v71
    ds_read2_b32 v[54:55], v71 offset0:0 offset1:1
    v_mad_u32_u24 v70, v13, 6, s69
    v_lshlrev_b32 v62, 3, v70
    v_and_b32 v70, -4, v70
    ds_read2_b32 v[58:59], v70 offset0:0 offset1:1
    v_mad_u32_u24 v71, v19, 6, s69
    v_lshlrev_b32 v63, 3, v71
    v_and_b32 v71, -4, v71
    ds_read2_b32 v[60:61], v71 offset0:0 offset1:1
    s_waitcnt lgkmcnt(6)
    v_alignbit_b32 v73, v41, v40, v44
    v_lshrrev_b32 v74, v44, v41
    v_lshlrev_b32 v72, 16, v73
    v_and_b32 v73, 0xffff0000, v73
    v_lshlrev_b32 v74, 16, v74
    v_alignbit_b32 v76, v43, v42, v45
    v_lshrrev_b32 v77, v45, v43
    v_lshlrev_b32 v75, 16, v76
    v_and_b32 v76, 0xffff0000, v76
    v_lshlrev_b32 v77, 16, v77
    v_sub_f32 v72, v72, v75
    v_sub_f32 v73, v73, v76
    v_sub_f32 v74, v74, v77
    v_mul_f32 v72, v72, v72
    v_fmac_f32 v72, v73, v73
    v_fmac_f32 v72, v74, v74
    v_mul_u32_u24 v78, s52, v16
    v_lshrrev_b32 v78, 18, v78
    v_and_b32 v78, -4, v78
    v_cmp_nge_f32 s[44:45], v72, s70
    v_cmp_class_f32 vcc, v72, v9
    v_lshl_or_b32 v10, v16, 16, v10
    v_mov_b32 v79, s71
    s_or_b64 s[44:45], s[44:45], vcc
    s_mov_b64 exec, s[44:45]
    ds_add_rtn_u32 v22, v78, v8 offset:0
    s_mov_b64 exec, -1
    v_mbcnt_lo_u32_b32 v79, s44, v79
    v_mbcnt_hi_u32_b32 v28, s45, v79
    s_bcnt1_i32_b64 s74, s[44:45]
    s_add_u32 s71, s71, s74
    s_waitcnt lgkmcnt(5)
    v_alignbit_b32 v73, v47, v46, v50
    v_lshrrev_b32 v74, v50, v47
    v_lshlrev_b32 v72, 16, v73
    v_and_b32 v73, 0xffff0000, v73
    v_lshlrev_b32 v74, 16, v74
    v_alignbit_b32 v76, v49, v48, v51
    v_lshrrev_b32 v77, v51, v49
    v_lshlrev_b32 v75, 16, v76
    v_and_b32 v76, 0xffff0000, v76
    v_lshlrev_b32 v77, 16, v77
    v_sub_f32 v72, v72, v75
    v_sub_f32 v73, v73, v76
    v_sub_f32 v74, v74, v77
    v_mul_f32 v72, v72, v72
    v_fmac_f32 v72, v73, v73
    v_fmac_f32 v72, v74, v74
    v_mul_u32_u24 v78, s52, v17
    v_lshrrev_b32 v78, 18, v78
    v_and_b32 v78, -4, v78
    v_cmp_nge_f32 s[46:47], v72, s70
    v_cmp_class_f32 vcc, v72, v9
    v_lshl_or_b32 v11, v17, 16, v11
    v_mov_b32 v79, s71
    s_or_b64 s[46:47], s[46:47], vcc
    s_mov_b64 exec, s[46:47]
    ds_add_rtn_u32 v23, v78, v8 offset:0
    s_mov_b64 exec, -1
    v_mbcnt_lo_u32_b32 v79, s46, v79
    v_mbcnt_hi_u32_b32 v29, s47, v79
    s_bcnt1_i32_b64 s74, s[46:47]
    s_add_u32 s71, s71, s74
    s_waitcnt lgkmcnt(4)
    v_alignbit_b32 v73, v53, v52, v56
    v_lshrrev_b32 v74, v56, v53
    v_lshlrev_b32 v72, 16, v73
    v_and_b32 v73, 0xffff0000, v73
    v_lshlrev_b32 v74, 16, v74
    v_alignbit_b32 v76, v55, v54, v57
    v_lshrrev_b32 v77, v57, v55
    v_lshlrev_b32 v75, 16, v76
    v_and_b32 v76, 0xffff0000, v76
    v_lshlrev_b32 v77, 16, v77
    v_sub_f32 v72, v72, v75
    v_sub_f32 v73, v73, v76
    v_sub_f32 v74, v74, v77
    v_mul_f32 v72, v72, v72
    v_fmac_f32 v72, v73, v73
    v_fmac_f32 v72, v74, v74
    v_mul_u32_u24 v78, s52, v18
    v_lshrrev_b32 v78, 18, v78
    v_and_b32 v78, -4, v78
    v_cmp_nge_f32 s[48:49], v72, s70
    v_cmp_class_f32 vcc, v72, v9
    v_lshl_or_b32 v12, v18, 16, v12
    v_mov_b32 v79, s71
    s_or_b64 s[48:49], s[48:49], vcc
    s_mov_b64 exec, s[48:49]
    ds_add_rtn_u32 v24, v78, v8 offset:0
    s_mov_b64 exec, -1
    v_mbcnt_lo_u32_b32 v79, s48, v79
    v_mbcnt_hi_u32_b32 v30, s49, v79
    s_bcnt1_i32_b64 s74, s[48:49]
    s_add_u32 s71, s71, s74
    s_waitcnt lgkmcnt(3)
    v_alignbit_b32 v73, v59, v58, v62
    v_lshrrev_b32 v74, v62, v59
    v_lshlrev_b32 v72, 16, v73
    v_and_b32 v73, 0xffff0000, v73
    v_lshlrev_b32 v74, 16, v74
    v_alignbit_b32 v76, v61, v60, v63
    v_lshrrev_b32 v77, v63, v61
    v_lshlrev_b32 v75, 16, v76
    v_and_b32 v76, 0xffff0000, v76
    v_lshlrev_b32 v77, 16, v77
    v_sub_f32 v72, v72, v75
    v_sub_f32 v73, v73, v76
    v_sub_f32 v74, v74, v77
    v_mul_f32 v72, v72, v72
    v_fmac_f32 v72, v73, v73
    v_fmac_f32 v72, v74, v74
    v_mul_u32_u24 v78, s52, v19
    v_lshrrev_b32 v78, 18, v78
    v_and_b32 v78, -4, v78
    v_cmp_nge_f32 s[50:51], v72, s70
    v_cmp_class_f32 vcc, v72, v9
    v_lshl_or_b32 v13, v19, 16, v13
    v_mov_b32 v79, s71
    s_or_b64 s[50:51], s[50:51], vcc
    s_mov_b64 exec, s[50:51]
    ds_add_rtn_u32 v25, v78, v8 offset:0
    s_mov_b64 exec, -1
    v_mbcnt_lo_u32_b32 v79, s50, v79
    v_mbcnt_hi_u32_b32 v31, s51, v79
    s_bcnt1_i32_b64 s74, s[50:51]
    s_add_u32 s71, s71, s74
    v_mov_b32 v70, 0
    v_mov_b32 v71, s71
    s_mov_b64 exec, 1
    ds_add_rtn_u32 v72, v70, v71 offset:5120
    s_mov_b64 exec, -1
    s_waitcnt lgkmcnt(0)
    v_readfirstlane_b32 s71, v72
    s_nop 1
    v_add_lshl_u32 v70, v28, s71, 3
    v_mov_b32 v72, v10
    v_mov_b32 v73, v22
    s_mov_b64 exec, s[44:45]
    ds_write_b64 v70, v[72:73] offset:5184
    s_mov_b64 exec, -1
    v_add_lshl_u32 v70, v29, s71, 3
    v_mov_b32 v72, v11
    v_mov_b32 v73, v23
    s_mov_b64 exec, s[46:47]
    ds_write_b64 v70, v[72:73] offset:5184
    s_mov_b64 exec, -1
    v_add_lshl_u32 v70, v30, s71, 3
    v_mov_b32 v72, v12
    v_mov_b32 v73, v24
    s_mov_b64 exec, s[48:49]
    ds_write_b64 v70, v[72:73] offset:5184
    s_mov_b64 exec, -1
    v_add_lshl_u32 v70, v31, s71, 3
    v_mov_b32 v72, v13
    v_mov_b32 v73, v25
    s_mov_b64 exec, s[50:51]
    ds_write_b64 v70, v[72:73] offset:5184
    s_mov_b64 exec, -1
    s_lshl_b32 s74, s72, 16
    s_and_b32 s75, s72, 0xffff0000
    s_lshl_b32 s76, s73, 16
    s_and_b32 s77, s73, 0xffff0000
    s_mul_i32 s58, s2, 40960
    s_add_u32 s58, s58, 6291408
    s_mov_b32 s59, 0
    s_mov_b32 s53, 0x40a00000
    v_mov_b32 v10, v0
    v_mov_b32 v70, 0
    s_waitcnt lgkmcnt(0)
    s_barrier
    ds_read_b32 v11, v70 offset:5120
    s_cmp_lg_u32 s20, 9
    s_cbranch_scc1 K1E_SCAN_DONE
    v_and_b32 v69, 63, v0
    v_mul_u32_u24 v70, 48, v69
    ds_read_b128 v[40:43], v70 offset:0
    ds_read_b128 v[44:47], v70 offset:16
    ds_read_b128 v[48:51], v70 offset:32
    s_waitcnt lgkmcnt(0)
    v_cmp_lt_u32 vcc, 4, v40
    v_subrev_u32 v52, 3, v40
    s_nop 0
    v_cndmask_b32 v52, 0, v52, vcc
    v_cmp_lt_u32 vcc, 4, v41
    v_subrev_u32 v53, 3, v41
    s_nop 0
    v_cndmask_b32 v53, 0, v53, vcc
    v_cmp_lt_u32 vcc, 4, v42
    v_subrev_u32 v54, 3, v42
    s_nop 0
    v_cndmask_b32 v54, 0, v54, vcc
    v_cmp_lt_u32 vcc, 4, v43
    v_subrev_u32 v55, 3, v43
    s_nop 0
    v_cndmask_b32 v55, 0, v55, vcc
    v_cmp_lt_u32 vcc, 4, v44
    v_subrev_u32 v56, 3, v44
    s_nop 0
    v_cndmask_b32 v56, 0, v56, vcc
    v_cmp_lt_u32 vcc, 4, v45
    v_subrev_u32 v57, 3, v45
    s_nop 0
    v_cndmask_b32 v57, 0, v57, vcc
    v_cmp_lt_u32 vcc, 4, v46
    v_subrev_u32 v58, 3, v46
    s_nop 0
    v_cndmask_b32 v58, 0, v58, vcc
    v_cmp_lt_u32 vcc, 4, v47
    v_subrev_u32 v59, 3, v47
    s_nop 0
    v_cndmask_b32 v59, 0, v59, vcc
    v_cmp_lt_u32 vcc, 4, v48
    v_subrev_u32 v60, 3, v48
    s_nop 0
    v_cndmask_b32 v60, 0, v60, vcc
    v_cmp_lt_u32 vcc, 4, v49
    v_subrev_u32 v61, 3, v49
    s_nop 0
    v_cndmask_b32 v61, 0, v61, vcc
    v_cmp_lt_u32 vcc, 4, v50
    v_subrev_u32 v62, 3, v50
    s_nop 0
    v_cndmask_b32 v62, 0, v62, vcc
    v_cmp_lt_u32 vcc, 4, v51
    v_subrev_u32 v63, 3, v51
    s_nop 0
    v_cndmask_b32 v63, 0, v63, vcc
    v_add_u32 v71, v52, v53
    v_add_u32 v71, v71, v54
    v_add_u32 v71, v71, v55
    v_add_u32 v71, v71, v56
    v_add_u32 v71, v71, v57
    v_add_u32 v71, v71, v58
    v_add_u32 v71, v71, v59
    v_add_u32 v71, v71, v60
    v_add_u32 v71, v71, v61
    v_add_u32 v71, v71, v62
    v_add_u32 v71, v71, v63
    v_mov_b32 v72, v71
    s_nop 1
    v_add_u32_dpp v72, v72, v72 row_shr:1 row_mask:0xf bank_mask:0xf bound_ctrl:0
    s_nop 1
    v_add_u32_dpp v72, v72, v72 row_shr:2 row_mask:0xf bank_mask:0xf bound_ctrl:0
    s_nop 1
    v_add_u32_dpp v72, v72, v72 row_shr:4 row_mask:0xf bank_mask:0xf bound_ctrl:0
    s_nop 1
    v_add_u32_dpp v72, v72, v72 row_shr:8 row_mask:0xf bank_mask:0xf bound_ctrl:0
    s_nop 1
    v_add_u32_dpp v72, v72, v72 row_bcast:15 row_mask:0xa bank_mask:0xf
    s_nop 1
    v_add_u32_dpp v72, v72, v72 row_bcast:31 row_mask:0xc bank_mask:0xf
    v_sub_u32 v73, v72, v71
    v_cmp_ne_u32 vcc, 0, v71
    v_mul_u32_u24 v74, 768, v69
    s_cmp_eq_u64 vcc, 0
    s_cbranch_scc1 K1E_SCAN_DONE
    v_mov_b32 v66, 0
    v_mov_b32 v67, 0x3ffe0000
    v_cmp_ne_u32 vcc, 0, v52
    v_mov_b32 v64, v73
    v_mov_b32 v65, v52
    v_lshl_or_b32 v40, v73, 16, v40
    s_mov_b64 exec, vcc
    ds_write_b128 v74, v[64:67] offset:25712
    s_mov_b64 exec, -1
    v_add_u32 v73, v73, v52
    v_cmp_ne_u32 vcc, 0, v53
    v_mov_b32 v64, v73
    v_mov_b32 v65, v53
    v_lshl_or_b32 v41, v73, 16, v41
    s_mov_b64 exec, vcc
    ds_write_b128 v74, v[64:67] offset:25776
    s_mov_b64 exec, -1
    v_add_u32 v73, v73, v53
    v_cmp_ne_u32 vcc, 0, v54
    v_mov_b32 v64, v73
    v_mov_b32 v65, v54
    v_lshl_or_b32 v42, v73, 16, v42
    s_mov_b64 exec, vcc
    ds_write_b128 v74, v[64:67] offset:25840
    s_mov_b64 exec, -1
    v_add_u32 v73, v73, v54
    v_cmp_ne_u32 vcc, 0, v55
    v_mov_b32 v64, v73
    v_mov_b32 v65, v55
    v_lshl_or_b32 v43, v73, 16, v43
    s_mov_b64 exec, vcc
    ds_write_b128 v74, v[64:67] offset:25904
    s_mov_b64 exec, -1
    v_add_u32 v73, v73, v55
    v_cmp_ne_u32 vcc, 0, v56
    v_mov_b32 v64, v73
    v_mov_b32 v65, v56
    v_lshl_or_b32 v44, v73, 16, v44
    s_mov_b64 exec, vcc
    ds_write_b128 v74, v[64:67] offset:25968
    s_mov_b64 exec, -1
    v_add_u32 v73, v73, v56
    v_cmp_ne_u32 vcc, 0, v57
    v_mov_b32 v64, v73
    v_mov_b32 v65, v57
    v_lshl_or_b32 v45, v73, 16, v45
    s_mov_b64 exec, vcc
    ds_write_b128 v74, v[64:67] offset:26032
    s_mov_b64 exec, -1
    v_add_u32 v73, v73, v57
    v_cmp_ne_u32 vcc, 0, v58
    v_mov_b32 v64, v73
    v_mov_b32 v65, v58
    v_lshl_or_b32 v46, v73, 16, v46
    s_mov_b64 exec, vcc
    ds_write_b128 v74, v[64:67] offset:26096
    s_mov_b64 exec, -1
    v_add_u32 v73, v73, v58
    v_cmp_ne_u32 vcc, 0, v59
    v_mov_b32 v64, v73
    v_mov_b32 v65, v59
    v_lshl_or_b32 v47, v73, 16, v47
    s_mov_b64 exec, vcc
    ds_write_b128 v74, v[64:67] offset:26160
    s_mov_b64 exec, -1
    v_add_u32 v73, v73, v59
    v_cmp_ne_u32 vcc, 0, v60
    v_mov_b32 v64, v73
    v_mov_b32 v65, v60
    v_lshl_or_b32 v48, v73, 16, v48
    s_mov_b64 exec, vcc
    ds_write_b128 v74, v[64:67] offset:26224
    s_mov_b64 exec, -1
    v_add_u32 v73, v73, v60
    v_cmp_ne_u32 vcc, 0, v61
    v_mov_b32 v64, v73
    v_mov_b32 v65, v61
    v_lshl_or_b32 v49, v73, 16, v49
    s_mov_b64 exec, vcc
    ds_write_b128 v74, v[64:67] offset:26288
    s_mov_b64 exec, -1
    v_add_u32 v73, v73, v61
    v_cmp_ne_u32 vcc, 0, v62
    v_mov_b32 v64, v73
    v_mov_b32 v65, v62
    v_lshl_or_b32 v50, v73, 16, v50
    s_mov_b64 exec, vcc
    ds_write_b128 v74, v[64:67] offset:26352
    s_mov_b64 exec, -1
    v_add_u32 v73, v73, v62
    v_cmp_ne_u32 vcc, 0, v63
    v_mov_b32 v64, v73
    v_mov_b32 v65, v63
    v_lshl_or_b32 v51, v73, 16, v51
    s_mov_b64 exec, vcc
    ds_write_b128 v74, v[64:67] offset:26416
    s_mov_b64 exec, -1
    ds_write_b128 v70, v[40:43] offset:0
    ds_write_b128 v70, v[44:47] offset:16
    ds_write_b128 v70, v[48:51] offset:32
K1E_SCAN_DONE:
    s_waitcnt lgkmcnt(0)
    v_readfirstlane_b32 s71, v11
K1E_LOOP:
    s_nop 1
    v_cmp_gt_u32 vcc, s71, v10
    s_and_saveexec_b64 s[54:55], vcc
    s_cbranch_execz K1E_MATHQ
    v_lshlrev_b32 v11, 3, v10
    ds_read_b64 v[12:13], v11 offset:5184
    s_waitcnt lgkmcnt(0)
    v_and_b32 v19, 0xffff, v12
    v_lshrrev_b32 v14, 16, v12
    v_mad_u32_u24 v15, v19, 6, s69
    v_lshlrev_b32 v16, 3, v15
    v_and_b32 v15, -4, v15
    ds_read2_b32 v[20:21], v15 offset0:0 offset1:1
    v_mad_u32_u24 v17, v14, 6, s69
    v_lshlrev_b32 v18, 3, v17
    v_and_b32 v17, -4, v17
    ds_read2_b32 v[22:23], v17 offset0:0 offset1:1
    v_mul_u32_u24 v47, s52, v14
    v_lshrrev_b32 v47, 20, v47
    v_mul_u32_u24 v46, 20, v47
    v_sub_u32 v14, v14, v46
    v_and_b32 v46, 3, v14
    v_lshl_or_b32 v44, v46, 14, v19
    v_lshlrev_b32 v44, 16, v44
    v_bfe_u32 v46, v14, 4, 1
    v_lshl_or_b32 v44, v46, 14, v44
    v_bfe_u32 v45, v14, 2, 1
    v_bfe_u32 v46, v14, 3, 1
    v_lshlrev_b32 v45, 14, v45
    v_lshl_or_b32 v45, v46, 30, v45
    s_waitcnt lgkmcnt(0)
    v_alignbit_b32 v25, v21, v20, v16
    v_lshrrev_b32 v26, v16, v21
    v_lshlrev_b32 v24, 16, v25
    v_and_b32 v25, 0xffff0000, v25
    v_lshlrev_b32 v26, 16, v26
    v_alignbit_b32 v28, v23, v22, v18
    v_lshrrev_b32 v29, v18, v23
    v_lshlrev_b32 v27, 16, v28
    v_and_b32 v28, 0xffff0000, v28
    v_lshlrev_b32 v29, 16, v29
    v_sub_f32 v24, v24, v27
    v_sub_f32 v25, v25, v28
    v_sub_f32 v26, v26, v29
    v_cvt_pk_bf16_f32 v27, v24, v25
    v_cvt_pk_bf16_f32 v28, v26, v26
    v_lshlrev_b32 v24, 16, v27
    v_and_b32 v25, 0xffff0000, v27
    v_lshlrev_b32 v26, 16, v28
    v_mul_f32 v27, v24, v24
    v_mul_f32 v28, v25, v25
    v_mul_f32 v29, v26, v26
    v_cvt_pk_bf16_f32 v27, v27, v28
    v_cvt_pk_bf16_f32 v29, v29, v29
    v_and_b32 v28, 0xffff0000, v27
    v_lshlrev_b32 v27, 16, v27
    v_lshlrev_b32 v29, 16, v29
    v_add_f32 v27, v27, v28
    v_add_f32 v27, v27, v29
    v_cvt_pk_bf16_f32 v27, v27, v27
    v_lshlrev_b32 v27, 16, v27
    v_add_f32 v27, 0x322bcc77, v27
    v_cvt_pk_bf16_f32 v27, v27, v27
    v_lshlrev_b32 v27, 16, v27
    v_sqrt_f32 v27, v27
    s_nop 0
    v_cvt_pk_bf16_f32 v27, v27, v27
    v_lshlrev_b32 v27, 16, v27
    v_rcp_f32 v28, v27
    v_mul_f32 v30, s74, v27
    v_mul_f32 v31, s75, v27
    v_mul_f32 v32, s76, v27
    v_mul_f32 v33, s77, v27
    v_mul_f32 v34, 0x40490fdb, v27
    v_cvt_pk_bf16_f32 v30, v30, v31
    v_cvt_pk_bf16_f32 v32, v32, v33
    v_cvt_pk_bf16_f32 v34, v34, v34
    v_lshlrev_b32 v34, 16, v34
    v_and_b32 v31, 0xffff0000, v30
    v_lshlrev_b32 v30, 16, v30
    v_and_b32 v33, 0xffff0000, v32
    v_lshlrev_b32 v32, 16, v32
    v_mul_f32 v34, 0x3e4ccccd, v34
    v_cvt_pk_bf16_f32 v34, v34, v34
    v_lshlrev_b32 v34, 16, v34
    v_mul_f32 v30, 0.15915494, v30
    v_mul_f32 v31, 0.15915494, v31
    v_mul_f32 v32, 0.15915494, v32
    v_mul_f32 v33, 0.15915494, v33
    v_mul_f32 v34, 0.15915494, v34
    v_fract_f32 v30, v30
    v_fract_f32 v31, v31
    v_fract_f32 v32, v32
    v_fract_f32 v33, v33
    v_fract_f32 v34, v34
    v_sin_f32 v30, v30
    v_sin_f32 v31, v31
    v_sin_f32 v32, v32
    v_sin_f32 v33, v33
    v_cos_f32 v34, v34
    v_mul_f32 v24, v24, v28
    v_mul_f32 v25, v25, v28
    v_mul_f32 v26, v26, v28
    v_cvt_pk_bf16_f32 v30, v30, v31
    v_cvt_pk_bf16_f32 v32, v32, v33
    v_cvt_pk_bf16_f32 v34, v34, v34
    v_lshlrev_b32 v34, 16, v34
    v_and_b32 v31, 0xffff0000, v30
    v_lshlrev_b32 v30, 16, v30
    v_and_b32 v33, 0xffff0000, v32
    v_lshlrev_b32 v32, 16, v32
    v_add_f32 v34, 1.0, v34
    v_cvt_pk_bf16_f32 v34, v34, v34
    v_lshlrev_b32 v34, 16, v34
    v_mul_f32 v30, v30, v28
    v_mul_f32 v31, v31, v28
    v_mul_f32 v32, v32, v28
    v_mul_f32 v33, v33, v28
    v_mul_f32 v34, 0.5, v34
    v_mul_f32 v35, 0, v27
    v_cmp_gt_f32 vcc, s53, v27
    v_cvt_pk_bf16_f32 v30, v30, v31
    v_cvt_pk_bf16_f32 v32, v32, v33
    v_cndmask_b32 v34, v35, v34, vcc
    v_cvt_pk_bf16_f32 v42, v24, v25
    v_cvt_pk_bf16_f32 v43, v26, v26
    v_and_b32 v31, 0xffff0000, v30
    v_lshlrev_b32 v30, 16, v30
    v_and_b32 v33, 0xffff0000, v32
    v_lshlrev_b32 v32, 16, v32
    v_mul_f32 v30, v30, v34
    v_mul_f32 v31, v31, v34
    v_mul_f32 v32, v32, v34
    v_mul_f32 v33, v33, v34
    v_cmp_o_f32 s[56:57], v35, v35
    v_and_b32 v42, 0xbfffbfff, v42
    v_and_b32 v43, 0xbfff, v43
    v_cvt_pk_bf16_f32 v40, v30, v31
    v_cvt_pk_bf16_f32 v41, v32, v33
    s_andn2_b64 s[56:57], s[56:57], vcc
    v_or_b32 v42, v42, v45
    v_or_b32 v43, v44, v43
    v_lshlrev_b32 v15, 2, v47
    v_cndmask_b32 v43, v43, -1, s[56:57]
K1E_MATHQ:
    s_mov_b64 s[56:57], exec
    s_mov_b64 exec, -1
    s_cmp_lg_u32 s59, 0
    s_cbranch_scc1 K1E_NOBAR
    s_barrier
K1E_NOBAR:
    s_mov_b64 exec, s[56:57]
    s_cbranch_execz K1E_NEXT
    ds_read_b32 v16, v15 offset:0
    v_lshlrev_b32 v17, 4, v15
    v_lshl_add_u32 v17, v13, 4, v17
    v_cmp_gt_u32 s[56:57], 3, v13
    s_waitcnt lgkmcnt(0)
    v_and_b32 v18, 0xffff, v16
    v_lshrrev_b32 v16, 16, v16
    v_cmp_gt_u32 vcc, 5, v18
    v_add_lshl_u32 v16, v16, v13, 4
    s_or_b64 vcc, vcc, s[56:57]
    s_mov_b64 s[56:57], exec
    s_and_b64 exec, exec, vcc
    ds_write_b128 v17, v[40:43] offset:25664
    s_andn2_b64 exec, s[56:57], vcc
    s_cbranch_execz K1E_NEXT
    buffer_store_dwordx4 v[40:43], v16, s[36:39], s58 offen sc1
K1E_NEXT:
    s_mov_b64 exec, -1
    v_add_u32 v10, 640, v10
    s_add_u32 s59, s59, 640
    s_cmp_lt_u32 s59, s71
    s_cbranch_scc1 K1E_LOOP
    s_lshl_b32 s64, s2, 15
    v_cmp_gt_u32 vcc, 80, v0
    s_waitcnt lgkmcnt(0)
    s_barrier
    ds_read_b128 v[40:43], v2 offset:25664
    ds_read_b128 v[44:47], v2 offset:35904
    ds_read_b128 v[48:51], v2 offset:46144
    ds_read_b128 v[52:55], v2 offset:56384
    s_waitcnt lgkmcnt(3)
    buffer_store_dwordx4 v[40:43], v2, s[36:39], s64 offen sc1
    s_add_u32 s64, s64, 10240
    s_waitcnt lgkmcnt(2)
    buffer_store_dwordx4 v[44:47], v2, s[36:39], s64 offen sc1
    s_add_u32 s64, s64, 10240
    s_waitcnt lgkmcnt(1)
    buffer_store_dwordx4 v[48:51], v2, s[36:39], s64 offen sc1
    s_add_u32 s64, s64, 10240
    s_waitcnt lgkmcnt(0)
    s_and_b64 exec, exec, vcc
    s_cbranch_execz K1E_FIN
    buffer_store_dwordx4 v[52:55], v2, s[36:39], s64 offen sc1
K1E_FIN:
    s_mov_b64 exec, -1
    s_mov_b32 s22, 0
    s_branch PHASE_B
PHASE_B:
    s_mov_b32 s3, s20
    s_mov_b32 s64, s21
    s_mov_b32 s65, s22
    s_lshl_b32 s62, s20, 3
    s_add_u32 s62, s62, s22
    s_lshl_b32 s2, s21, 1
    s_add_u32 s14, s2, 1
    s_sub_u32 s2, s2, 250
    s_cmp_eq_u32 s22, 0
    s_cselect_b32 s2, s14, s2
    s_mov_b32 s20, s94
    s_mov_b32 s21, s95
    s_mov_b32 s22, 0xc00
    s_mov_b32 s23, 0x20000
    s_mov_b32 s16, s4
    s_mov_b32 s17, s5
    s_mov_b32 s18, 0x9c4000
    s_mov_b32 s19, 0x20000
    s_mov_b32 s68, s98
    s_mov_b32 s69, s99
    s_mov_b32 s70, 0x100
    s_mov_b32 s71, 0x20000
    v_mov_b32 v88, s65
    v_mov_b32 v89, 1
    v_bfe_u32 v59, v0, 4, 2
    v_and_b32 v1, 15, v0
    v_lshlrev_b32 v98, 4, v1
    v_mul_u32_u24 v102, 768, v59
    v_add_u32 v102, v102, v98
    s_lshl_b32 s14, s3, 8
    buffer_load_dwordx4 v[66:69], v102, s[20:23], s14 offen
    s_mul_i32 s40, s2, 40
    s_lshl_b32 s41, s3, 2
    s_add_u32 s40, s40, s41
    v_add_u32 v99, s40, v59
    v_lshlrev_b32 v99, 10, v99
    v_add_u32 v99, v99, v98
    s_cmp_eq_u32 s3, 8
    s_cbranch_scc0 PB_NP
    v_mov_b32 v88, 0
    buffer_load_dword v89, v88, s[68:71], 0 offen offset:128 sc1
    s_waitcnt vmcnt(0)
    v_readfirstlane_b32 s61, v89
PB_NP:
    s_waitcnt vmcnt(1)
    s_barrier
    s_cmp_lg_u32 s3, 9
    s_cbranch_scc1 PB_NA
    s_mov_b64 exec, 1
    buffer_atomic_add v89, v88, s[68:71], 0 offen sc0 sc1
    s_mov_b64 exec, -1
PB_NA:
    v_lshrrev_b32 v1, 3, v0
    v_and_b32 v103, 7, v0
    v_lshlrev_b32 v103, 4, v103
    v_lshl_add_u32 v103, v1, 15, v103
    s_lshl_b32 s15, s2, 7
    v_add_u32 v103, s15, v103
    s_mov_b32 s36, 2621440
    s_mov_b32 s37, 0x600000
    s_add_u32 s32, s100, 0x1000000
    s_addc_u32 s33, s101, 0
    s_mov_b32 s34, 0xae2000
    s_mov_b32 s35, 0x20000
    s_mov_b32 s28, s100
    s_mov_b32 s29, s101
    s_mov_b32 s30, 0xc35000
    s_mov_b32 s31, 0x20000
    s_mov_b32 s24, s96
    s_mov_b32 s25, s97
    s_mov_b32 s26, 0x9c4000
    s_mov_b32 s27, 0x20000
    s_mov_b32 s46, 0x05040100
    s_mov_b32 s47, 0x07060302
    s_mov_b32 s48, 0x7fffff00
    s_mov_b32 s49, 1280
    s_mov_b32 s44, 10000
    s_mov_b32 s45, 0x3ffe
    v_mov_b32 v100, 0
    v_mov_b32 v101, 0
    s_mov_b64 s[38:39], 0
    v_cmp_lt_u32 vcc, 359, v0
    s_mov_b64 s[42:43], vcc
    v_mov_b32 v50, 0
    v_mov_b32 v51, 0
    v_mov_b32 v52, 0
    v_mov_b32 v53, 0
    v_lshlrev_b32 v54, 4, v0
    v_add_u32 v57, 40960, v54
    v_lshlrev_b32 v55, 2, v0
    v_mov_b32 v56, s48
    v_mov_b32 v60, 1
    ds_write_b128 v54, v[50:53] offset:8768
    ds_write_b128 v54, v[50:53] offset:19008
    ds_write_b128 v54, v[50:53] offset:29248
    ds_write_b128 v54, v[50:53] offset:39488
    ds_write_b128 v57, v[50:53] offset:8768
    ds_write_b128 v57, v[50:53] offset:19008
    ds_write_b128 v57, v[50:53] offset:29248
    ds_write_b128 v57, v[50:53] offset:39488
    ds_write_b32 v55, v56 offset:0
    ds_write_b128 v50, v[50:53] offset:8704
    ds_write_b128 v50, v[50:53] offset:8720
    ds_write_b128 v50, v[50:53] offset:8736
    s_mov_b32 s57, 0
    s_cmp_lg_u32 s3, 8
    s_cbranch_scc1 PB_N9
    s_cmp_lg_u32 s61, 0
    s_cbranch_scc1 PB_N9
    s_mov_b32 s66, 0
    v_mov_b32 v88, 0
PB_PE:
    buffer_load_dword v89, v88, s[68:71], 0 offen offset:128 sc1
    s_add_u32 s66, s66, 1
    s_waitcnt vmcnt(0)
    v_readfirstlane_b32 s67, v89
    s_cmp_lg_u32 s67, 0
    s_cbranch_scc1 PB_PE_D
    s_cmp_lt_u32 s66, 0x40000
    s_sleep 1
    s_cbranch_scc1 PB_PE
PB_PE_D:
PB_N9:
    s_cmp_ge_u32 s3, 3
    s_cbranch_scc1 K2_WDONE
    s_waitcnt vmcnt(0)
    s_lshl_b32 s14, s3, 11
    v_lshl_add_u32 v1, v59, 2, v98
    v_add_u32 v1, s14, v1
    v_lshlrev_b32 v70, 16, v66
    v_and_b32 v71, 0xffff0000, v66
    v_lshlrev_b32 v72, 16, v67
    v_and_b32 v73, 0xffff0000, v67
    v_lshlrev_b32 v74, 16, v68
    v_and_b32 v75, 0xffff0000, v68
    v_lshlrev_b32 v76, 16, v69
    v_and_b32 v77, 0xffff0000, v69
    ds_write_b32 v1, v70 offset:2560
    ds_write_b32 v1, v71 offset:2816
    ds_write_b32 v1, v72 offset:3072
    ds_write_b32 v1, v73 offset:3328
    ds_write_b32 v1, v74 offset:3584
    ds_write_b32 v1, v75 offset:3840
    ds_write_b32 v1, v76 offset:4096
    ds_write_b32 v1, v77 offset:4352
K2_WDONE:
    s_waitcnt lgkmcnt(0)
    s_cmp_lg_u32 s62, 72
    s_cbranch_scc1 PB_NL0
    s_waitcnt vmcnt(0)
    v_readfirstlane_b32 s67, v89
    s_cmp_lg_u32 s67, 124
    s_cbranch_scc1 PB_NL0
    v_mov_b32 v89, 1
    s_mov_b64 exec, 1
    buffer_store_dword v89, v88, s[68:71], 0 offen offset:128 sc1
    s_mov_b64 exec, -1
PB_NL0:
    s_barrier
    buffer_load_dwordx4 v[104:107], v103, s[32:35], 0 offen sc1
    buffer_load_dwordx4 v[108:111], v103, s[32:35], s36 offen sc1
    s_cmp_eq_u32 s65, 0
    s_cbranch_scc1 PB_W8B
    s_cmp_lg_u32 s62, 76
    s_cbranch_scc1 PB_NL1
    s_waitcnt vmcnt(2)
    v_readfirstlane_b32 s67, v89
    s_cmp_lg_u32 s67, 124
    s_cbranch_scc1 PB_NL1
    v_mov_b32 v89, 1
    s_mov_b64 exec, 1
    buffer_store_dword v89, v88, s[68:71], 0 offen offset:128 sc1
    s_mov_b64 exec, -1
PB_NL1:
    s_waitcnt vmcnt(0)
    s_branch PB_C
PB_W8B:
    buffer_load_dwordx4 v[18:21], v99, s[16:19], 0 offen offset:0
    buffer_load_dwordx4 v[22:25], v99, s[16:19], 0 offen offset:256
    buffer_load_dwordx4 v[26:29], v99, s[16:19], 0 offen offset:512
    buffer_load_dwordx4 v[30:33], v99, s[16:19], 0 offen offset:768
    s_waitcnt vmcnt(4)
PB_C:
    s_mov_b32 s72, s65
    v_bfe_u32 v1, v107, 16, 14
    v_cmp_eq_u32 s[50:51], s45, v1
    s_andn2_b64 s[50:51], s[50:51], s[38:39]
    s_mov_b64 s[60:61], 0
    s_cmp_eq_u64 s[50:51], 0
    s_cbranch_scc1 K2_M0
    v_cndmask_b32 v67, 0, v105, s[50:51]
    v_lshrrev_b32 v1, 3, v0
    v_add_u32 v66, 0, v1
    v_mov_b32_dpp v68, v104 quad_perm:[3,3,3,3] row_mask:0xf bank_mask:0xf
    v_mov_b32_dpp v69, v67 quad_perm:[3,3,3,3] row_mask:0xf bank_mask:0xf
    v_mul_u32_u24 v66, 2560, v66
    v_and_b32 v1, 3, v0
    v_add3_u32 v66, v66, v68, v1
    v_cmp_lt_u32 s[60:61], v1, v69
    v_lshlrev_b32 v66, 4, v66
    s_mov_b64 exec, s[60:61]
    buffer_load_dwordx4 v[120:123], v66, s[32:35], s37 offen sc1
    s_mov_b64 exec, -1
K2_M0:
    v_bfe_u32 v1, v111, 16, 14
    v_cmp_eq_u32 s[52:53], s45, v1
    s_andn2_b64 s[52:53], s[52:53], s[42:43]
    s_mov_b64 s[62:63], 0
    s_cmp_eq_u64 s[52:53], 0
    s_cbranch_scc1 K2_M1
    v_cndmask_b32 v67, 0, v109, s[52:53]
    v_lshrrev_b32 v1, 3, v0
    v_add_u32 v66, 80, v1
    v_mov_b32_dpp v68, v108 quad_perm:[3,3,3,3] row_mask:0xf bank_mask:0xf
    v_mov_b32_dpp v69, v67 quad_perm:[3,3,3,3] row_mask:0xf bank_mask:0xf
    v_mul_u32_u24 v66, 2560, v66
    v_and_b32 v1, 3, v0
    v_add3_u32 v66, v66, v68, v1
    v_cmp_lt_u32 s[62:63], v1, v69
    v_lshlrev_b32 v66, 4, v66
    s_mov_b64 exec, s[62:63]
    buffer_load_dwordx4 v[124:127], v66, s[32:35], s37 offen sc1
    s_mov_b64 exec, -1
K2_M1:
    v_bfe_u32 v1, v107, 16, 14
    v_cmp_gt_u32 vcc, s44, v1
    s_andn2_b64 vcc, vcc, s[38:39]
    s_mov_b64 exec, vcc
    s_cbranch_execz K2_F0
    v_bfe_u32 v66, v106, 14, 1
    v_bfe_u32 v68, v106, 30, 1
    v_lshlrev_b32 v66, 2, v66
    v_lshl_or_b32 v66, v68, 3, v66
    v_bfe_u32 v68, v107, 14, 1
    v_lshl_or_b32 v66, v68, 4, v66
    v_bfe_u32 v68, v0, 2, 1
    v_mad_u32_u24 v66, v68, 20, v66
    ds_add_rtn_u32 v67, v66, v60 offset:8704
    v_lshlrev_b32 v70, 16, v104
    v_and_b32 v71, 0xffff0000, v104
    v_lshlrev_b32 v72, 16, v105
    v_and_b32 v73, 0xffff0000, v105
    v_and_b32 v74, 0xbfff, v106
    v_lshlrev_b32 v74, 16, v74
    v_and_b32 v75, 0xbfff0000, v106
    v_and_b32 v76, 0xbfff, v107
    v_lshlrev_b32 v76, 16, v76
    v_mul_f32 v86, v70, v74
    v_mul_f32 v87, v71, v74
    v_mul_f32 v88, v72, v74
    v_mul_f32 v89, v73, v74
    v_cvt_pk_bf16_f32 v78, v86, v87
    v_cvt_pk_bf16_f32 v79, v88, v89
    v_mul_f32 v86, v70, v75
    v_mul_f32 v87, v71, v75
    v_mul_f32 v88, v72, v75
    v_mul_f32 v89, v73, v75
    v_cvt_pk_bf16_f32 v80, v86, v87
    v_cvt_pk_bf16_f32 v81, v88, v89
    v_mul_f32 v86, v70, v76
    v_mul_f32 v87, v71, v76
    v_mul_f32 v88, v72, v76
    v_mul_f32 v89, v73, v76
    v_cvt_pk_bf16_f32 v82, v86, v87
    v_cvt_pk_bf16_f32 v83, v88, v89
    v_bfe_u32 v77, v107, 16, 14
    v_mul_u32_u24 v77, s49, v77
    v_lshrrev_b32 v84, 30, v107
    v_lshlrev_b32 v84, 6, v84
    v_lshl_add_u32 v84, v66, 11, v84
    v_lshlrev_b32 v66, 6, v66
    s_waitcnt lgkmcnt(0)
    v_cmp_lt_u32 vcc, 63, v67
    v_and_b32 v68, 3, v67
    v_bfe_u32 v69, v67, 2, 3
    v_lshl_or_b32 v85, v68, 3, v69
    v_and_or_b32 v85, v67, 32, v85
    s_or_b64 s[50:51], s[50:51], vcc
    s_andn2_b64 exec, exec, vcc
    v_lshl_add_u32 v66, v85, 2, v66
    ds_write_b32 v66, v77 offset:0
    v_lshrrev_b32 v68, 3, v85
    v_lshl_add_u32 v68, v68, 8, v84
    v_lshl_add_u32 v68, v69, 1, v68
    ds_write_b16 v68, v104 offset:8768
    ds_write_b16_d16_hi v68, v104 offset:8784
    ds_write_b16 v68, v105 offset:8800
    ds_write_b16_d16_hi v68, v105 offset:8816
    ds_write_b16 v68, v78 offset:10816
    ds_write_b16_d16_hi v68, v78 offset:10832
    ds_write_b16 v68, v79 offset:10848
    ds_write_b16_d16_hi v68, v79 offset:10864
    ds_write_b16 v68, v80 offset:12864
    ds_write_b16_d16_hi v68, v80 offset:12880
    ds_write_b16 v68, v81 offset:12896
    ds_write_b16_d16_hi v68, v81 offset:12912
    ds_write_b16 v68, v82 offset:14912
    ds_write_b16_d16_hi v68, v82 offset:14928
    ds_write_b16 v68, v83 offset:14944
    ds_write_b16_d16_hi v68, v83 offset:14960
K2_F0:
    s_mov_b64 exec, -1
    v_bfe_u32 v1, v111, 16, 14
    v_cmp_gt_u32 vcc, s44, v1
    s_andn2_b64 vcc, vcc, s[42:43]
    s_mov_b64 exec, vcc
    s_cbranch_execz K2_F1
    v_bfe_u32 v66, v110, 14, 1
    v_bfe_u32 v68, v110, 30, 1
    v_lshlrev_b32 v66, 2, v66
    v_lshl_or_b32 v66, v68, 3, v66
    v_bfe_u32 v68, v111, 14, 1
    v_lshl_or_b32 v66, v68, 4, v66
    v_bfe_u32 v68, v0, 2, 1
    v_mad_u32_u24 v66, v68, 20, v66
    ds_add_rtn_u32 v67, v66, v60 offset:8704
    v_lshlrev_b32 v70, 16, v108
    v_and_b32 v71, 0xffff0000, v108
    v_lshlrev_b32 v72, 16, v109
    v_and_b32 v73, 0xffff0000, v109
    v_and_b32 v74, 0xbfff, v110
    v_lshlrev_b32 v74, 16, v74
    v_and_b32 v75, 0xbfff0000, v110
    v_and_b32 v76, 0xbfff, v111
    v_lshlrev_b32 v76, 16, v76
    v_mul_f32 v86, v70, v74
    v_mul_f32 v87, v71, v74
    v_mul_f32 v88, v72, v74
    v_mul_f32 v89, v73, v74
    v_cvt_pk_bf16_f32 v78, v86, v87
    v_cvt_pk_bf16_f32 v79, v88, v89
    v_mul_f32 v86, v70, v75
    v_mul_f32 v87, v71, v75
    v_mul_f32 v88, v72, v75
    v_mul_f32 v89, v73, v75
    v_cvt_pk_bf16_f32 v80, v86, v87
    v_cvt_pk_bf16_f32 v81, v88, v89
    v_mul_f32 v86, v70, v76
    v_mul_f32 v87, v71, v76
    v_mul_f32 v88, v72, v76
    v_mul_f32 v89, v73, v76
    v_cvt_pk_bf16_f32 v82, v86, v87
    v_cvt_pk_bf16_f32 v83, v88, v89
    v_bfe_u32 v77, v111, 16, 14
    v_mul_u32_u24 v77, s49, v77
    v_lshrrev_b32 v84, 30, v111
    v_lshlrev_b32 v84, 6, v84
    v_lshl_add_u32 v84, v66, 11, v84
    v_lshlrev_b32 v66, 6, v66
    s_waitcnt lgkmcnt(0)
    v_cmp_lt_u32 vcc, 63, v67
    v_and_b32 v68, 3, v67
    v_bfe_u32 v69, v67, 2, 3
    v_lshl_or_b32 v85, v68, 3, v69
    v_and_or_b32 v85, v67, 32, v85
    s_or_b64 s[52:53], s[52:53], vcc
    s_andn2_b64 exec, exec, vcc
    v_lshl_add_u32 v66, v85, 2, v66
    ds_write_b32 v66, v77 offset:0
    v_lshrrev_b32 v68, 3, v85
    v_lshl_add_u32 v68, v68, 8, v84
    v_lshl_add_u32 v68, v69, 1, v68
    ds_write_b16 v68, v108 offset:8768
    ds_write_b16_d16_hi v68, v108 offset:8784
    ds_write_b16 v68, v109 offset:8800
    ds_write_b16_d16_hi v68, v109 offset:8816
    ds_write_b16 v68, v78 offset:10816
    ds_write_b16_d16_hi v68, v78 offset:10832
    ds_write_b16 v68, v79 offset:10848
    ds_write_b16_d16_hi v68, v79 offset:10864
    ds_write_b16 v68, v80 offset:12864
    ds_write_b16_d16_hi v68, v80 offset:12880
    ds_write_b16 v68, v81 offset:12896
    ds_write_b16_d16_hi v68, v81 offset:12912
    ds_write_b16 v68, v82 offset:14912
    ds_write_b16_d16_hi v68, v82 offset:14928
    ds_write_b16 v68, v83 offset:14944
    ds_write_b16_d16_hi v68, v83 offset:14960
K2_F1:
    s_mov_b64 exec, -1
    s_or_b64 s[54:55], s[50:51], s[52:53]
    s_cmp_eq_u64 s[54:55], 0
    s_cbranch_scc1 K2_NOFLAG
    s_waitcnt vmcnt(0)
    s_cmp_eq_u64 s[60:61], 0
    s_cbranch_scc1 K2_N0
    v_bfe_u32 v1, v123, 16, 14
    v_cmp_gt_u32 vcc, s44, v1
    s_mov_b64 s[54:55], 0
    s_and_b64 exec, vcc, s[60:61]
    s_cbranch_execz K2_MQ0
    v_bfe_u32 v66, v122, 14, 1
    v_bfe_u32 v68, v122, 30, 1
    v_lshlrev_b32 v66, 2, v66
    v_lshl_or_b32 v66, v68, 3, v66
    v_bfe_u32 v68, v123, 14, 1
    v_lshl_or_b32 v66, v68, 4, v66
    v_bfe_u32 v68, v0, 2, 1
    v_mad_u32_u24 v66, v68, 20, v66
    ds_add_rtn_u32 v67, v66, v60 offset:8704
    v_lshlrev_b32 v70, 16, v120
    v_and_b32 v71, 0xffff0000, v120
    v_lshlrev_b32 v72, 16, v121
    v_and_b32 v73, 0xffff0000, v121
    v_and_b32 v74, 0xbfff, v122
    v_lshlrev_b32 v74, 16, v74
    v_and_b32 v75, 0xbfff0000, v122
    v_and_b32 v76, 0xbfff, v123
    v_lshlrev_b32 v76, 16, v76
    v_mul_f32 v86, v70, v74
    v_mul_f32 v87, v71, v74
    v_mul_f32 v88, v72, v74
    v_mul_f32 v89, v73, v74
    v_cvt_pk_bf16_f32 v78, v86, v87
    v_cvt_pk_bf16_f32 v79, v88, v89
    v_mul_f32 v86, v70, v75
    v_mul_f32 v87, v71, v75
    v_mul_f32 v88, v72, v75
    v_mul_f32 v89, v73, v75
    v_cvt_pk_bf16_f32 v80, v86, v87
    v_cvt_pk_bf16_f32 v81, v88, v89
    v_mul_f32 v86, v70, v76
    v_mul_f32 v87, v71, v76
    v_mul_f32 v88, v72, v76
    v_mul_f32 v89, v73, v76
    v_cvt_pk_bf16_f32 v82, v86, v87
    v_cvt_pk_bf16_f32 v83, v88, v89
    v_bfe_u32 v77, v123, 16, 14
    v_mul_u32_u24 v77, s49, v77
    v_lshrrev_b32 v84, 30, v123
    v_lshlrev_b32 v84, 6, v84
    v_lshl_add_u32 v84, v66, 11, v84
    v_lshlrev_b32 v66, 6, v66
    s_waitcnt lgkmcnt(0)
    v_cmp_lt_u32 vcc, 63, v67
    v_and_b32 v68, 3, v67
    v_bfe_u32 v69, v67, 2, 3
    v_lshl_or_b32 v85, v68, 3, v69
    v_and_or_b32 v85, v67, 32, v85
    s_or_b64 s[54:55], s[54:55], vcc
    s_andn2_b64 exec, exec, vcc
    v_lshl_add_u32 v66, v85, 2, v66
    ds_write_b32 v66, v77 offset:0
    v_lshrrev_b32 v68, 3, v85
    v_lshl_add_u32 v68, v68, 8, v84
    v_lshl_add_u32 v68, v69, 1, v68
    ds_write_b16 v68, v120 offset:8768
    ds_write_b16_d16_hi v68, v120 offset:8784
    ds_write_b16 v68, v121 offset:8800
    ds_write_b16_d16_hi v68, v121 offset:8816
    ds_write_b16 v68, v78 offset:10816
    ds_write_b16_d16_hi v68, v78 offset:10832
    ds_write_b16 v68, v79 offset:10848
    ds_write_b16_d16_hi v68, v79 offset:10864
    ds_write_b16 v68, v80 offset:12864
    ds_write_b16_d16_hi v68, v80 offset:12880
    ds_write_b16 v68, v81 offset:12896
    ds_write_b16_d16_hi v68, v81 offset:12912
    ds_write_b16 v68, v82 offset:14912
    ds_write_b16_d16_hi v68, v82 offset:14928
    ds_write_b16 v68, v83 offset:14944
    ds_write_b16_d16_hi v68, v83 offset:14960
K2_MQ0:
    s_mov_b64 exec, -1
    s_andn2_b64 s[54:55], s[60:61], s[54:55]
    v_and_b32 v1, 60, v0
    v_lshrrev_b64 v[66:67], v1, s[54:55]
    v_min_u32 v68, 15, v105
    v_and_b32 v66, 15, v66
    v_add_u32 v69, 1, v66
    v_bfe_u32 v69, v69, v68, 1
    v_lshlrev_b32 v100, 16, v66
    v_bfe_u32 v1, v107, 16, 14
    v_cmp_gt_u32 vcc, 5, v68
    v_cmp_eq_u32 s[54:55], s45, v1
    v_cmp_eq_u32 s[56:57], 1, v69
    s_and_b64 vcc, vcc, s[54:55]
    v_cndmask_b32 v100, 0, v100, s[54:55]
    s_and_b64 vcc, vcc, s[56:57]
    s_andn2_b64 s[50:51], s[50:51], vcc
K2_N0:
    s_cmp_eq_u64 s[62:63], 0
    s_cbranch_scc1 K2_N1
    v_bfe_u32 v1, v127, 16, 14
    v_cmp_gt_u32 vcc, s44, v1
    s_mov_b64 s[54:55], 0
    s_and_b64 exec, vcc, s[62:63]
    s_cbranch_execz K2_MQ1
    v_bfe_u32 v66, v126, 14, 1
    v_bfe_u32 v68, v126, 30, 1
    v_lshlrev_b32 v66, 2, v66
    v_lshl_or_b32 v66, v68, 3, v66
    v_bfe_u32 v68, v127, 14, 1
    v_lshl_or_b32 v66, v68, 4, v66
    v_bfe_u32 v68, v0, 2, 1
    v_mad_u32_u24 v66, v68, 20, v66
    ds_add_rtn_u32 v67, v66, v60 offset:8704
    v_lshlrev_b32 v70, 16, v124
    v_and_b32 v71, 0xffff0000, v124
    v_lshlrev_b32 v72, 16, v125
    v_and_b32 v73, 0xffff0000, v125
    v_and_b32 v74, 0xbfff, v126
    v_lshlrev_b32 v74, 16, v74
    v_and_b32 v75, 0xbfff0000, v126
    v_and_b32 v76, 0xbfff, v127
    v_lshlrev_b32 v76, 16, v76
    v_mul_f32 v86, v70, v74
    v_mul_f32 v87, v71, v74
    v_mul_f32 v88, v72, v74
    v_mul_f32 v89, v73, v74
    v_cvt_pk_bf16_f32 v78, v86, v87
    v_cvt_pk_bf16_f32 v79, v88, v89
    v_mul_f32 v86, v70, v75
    v_mul_f32 v87, v71, v75
    v_mul_f32 v88, v72, v75
    v_mul_f32 v89, v73, v75
    v_cvt_pk_bf16_f32 v80, v86, v87
    v_cvt_pk_bf16_f32 v81, v88, v89
    v_mul_f32 v86, v70, v76
    v_mul_f32 v87, v71, v76
    v_mul_f32 v88, v72, v76
    v_mul_f32 v89, v73, v76
    v_cvt_pk_bf16_f32 v82, v86, v87
    v_cvt_pk_bf16_f32 v83, v88, v89
    v_bfe_u32 v77, v127, 16, 14
    v_mul_u32_u24 v77, s49, v77
    v_lshrrev_b32 v84, 30, v127
    v_lshlrev_b32 v84, 6, v84
    v_lshl_add_u32 v84, v66, 11, v84
    v_lshlrev_b32 v66, 6, v66
    s_waitcnt lgkmcnt(0)
    v_cmp_lt_u32 vcc, 63, v67
    v_and_b32 v68, 3, v67
    v_bfe_u32 v69, v67, 2, 3
    v_lshl_or_b32 v85, v68, 3, v69
    v_and_or_b32 v85, v67, 32, v85
    s_or_b64 s[54:55], s[54:55], vcc
    s_andn2_b64 exec, exec, vcc
    v_lshl_add_u32 v66, v85, 2, v66
    ds_write_b32 v66, v77 offset:0
    v_lshrrev_b32 v68, 3, v85
    v_lshl_add_u32 v68, v68, 8, v84
    v_lshl_add_u32 v68, v69, 1, v68
    ds_write_b16 v68, v124 offset:8768
    ds_write_b16_d16_hi v68, v124 offset:8784
    ds_write_b16 v68, v125 offset:8800
    ds_write_b16_d16_hi v68, v125 offset:8816
    ds_write_b16 v68, v78 offset:10816
    ds_write_b16_d16_hi v68, v78 offset:10832
    ds_write_b16 v68, v79 offset:10848
    ds_write_b16_d16_hi v68, v79 offset:10864
    ds_write_b16 v68, v80 offset:12864
    ds_write_b16_d16_hi v68, v80 offset:12880
    ds_write_b16 v68, v81 offset:12896
    ds_write_b16_d16_hi v68, v81 offset:12912
    ds_write_b16 v68, v82 offset:14912
    ds_write_b16_d16_hi v68, v82 offset:14928
    ds_write_b16 v68, v83 offset:14944
    ds_write_b16_d16_hi v68, v83 offset:14960
K2_MQ1:
    s_mov_b64 exec, -1
    s_andn2_b64 s[54:55], s[62:63], s[54:55]
    v_and_b32 v1, 60, v0
    v_lshrrev_b64 v[66:67], v1, s[54:55]
    v_min_u32 v68, 15, v109
    v_and_b32 v66, 15, v66
    v_add_u32 v69, 1, v66
    v_bfe_u32 v69, v69, v68, 1
    v_lshlrev_b32 v101, 16, v66
    v_bfe_u32 v1, v111, 16, 14
    v_cmp_gt_u32 vcc, 5, v68
    v_cmp_eq_u32 s[54:55], s45, v1
    v_cmp_eq_u32 s[56:57], 1, v69
    s_and_b64 vcc, vcc, s[54:55]
    v_cndmask_b32 v101, 0, v101, s[54:55]
    s_and_b64 vcc, vcc, s[56:57]
    s_andn2_b64 s[52:53], s[52:53], vcc
K2_N1:
    s_mov_b32 s57, 0
    s_or_b64 s[54:55], s[50:51], s[52:53]
    s_cmp_eq_u64 s[54:55], 0
    s_cbranch_scc1 K2_NOFLAG
K2_SLOW:
    s_mov_b64 exec, -1
    v_add_u32 v114, 0, v103
    s_mov_b64 exec, s[50:51]
    s_cbranch_execz K2_S0Q
    buffer_load_dwordx4 v[104:107], v114, s[32:35], 0 offen sc1
    v_lshrrev_b32 v1, 3, v0
    v_add_u32 v112, 0, v1
    v_mul_u32_u24 v112, 2560, v112
    s_mov_b64 s[60:61], 0
    s_waitcnt vmcnt(0)
    v_bfe_u32 v1, v107, 16, 14
    v_cmp_eq_u32 vcc, s45, v1
    v_add_lshl_u32 v112, v112, v104, 4
    v_add_u32 v112, 0x600000, v112
    v_cndmask_b32 v112, v114, v112, vcc
    v_cndmask_b32 v113, 1, v105, vcc
    v_min_u32 v113, 2560, v113
K2_S0L:
    s_mov_b64 exec, s[50:51]
    v_and_b32 v1, 0xffff, v100
    v_cmp_lt_u32 vcc, v1, v113
    v_lshl_add_u32 v114, v1, 4, v112
    v_lshrrev_b32 v115, 16, v100
    v_min_u32 v1, 31, v1
    v_bfe_u32 v115, v115, v1, 1
    s_mov_b64 s[50:51], vcc
    s_andn2_b64 exec, vcc, s[60:61]
    s_cbranch_execz K2_S0Q
    buffer_load_dwordx4 v[104:107], v114, s[32:35], 0 offen sc1
    s_mov_b64 s[62:63], exec
    v_cmp_eq_u32 s[54:55], 0, v115
    s_waitcnt vmcnt(0)
    v_bfe_u32 v1, v107, 16, 14
    v_cmp_gt_u32 vcc, s44, v1
    s_and_b64 exec, exec, s[54:55]
    s_and_b64 exec, exec, vcc
    s_cbranch_execz K2_S0A
    v_bfe_u32 v66, v106, 14, 1
    v_bfe_u32 v68, v106, 30, 1
    v_lshlrev_b32 v66, 2, v66
    v_lshl_or_b32 v66, v68, 3, v66
    v_bfe_u32 v68, v107, 14, 1
    v_lshl_or_b32 v66, v68, 4, v66
    v_bfe_u32 v68, v0, 2, 1
    v_mad_u32_u24 v66, v68, 20, v66
    ds_add_rtn_u32 v67, v66, v60 offset:8704
    v_lshlrev_b32 v70, 16, v104
    v_and_b32 v71, 0xffff0000, v104
    v_lshlrev_b32 v72, 16, v105
    v_and_b32 v73, 0xffff0000, v105
    v_and_b32 v74, 0xbfff, v106
    v_lshlrev_b32 v74, 16, v74
    v_and_b32 v75, 0xbfff0000, v106
    v_and_b32 v76, 0xbfff, v107
    v_lshlrev_b32 v76, 16, v76
    v_mul_f32 v86, v70, v74
    v_mul_f32 v87, v71, v74
    v_mul_f32 v88, v72, v74
    v_mul_f32 v89, v73, v74
    v_cvt_pk_bf16_f32 v78, v86, v87
    v_cvt_pk_bf16_f32 v79, v88, v89
    v_mul_f32 v86, v70, v75
    v_mul_f32 v87, v71, v75
    v_mul_f32 v88, v72, v75
    v_mul_f32 v89, v73, v75
    v_cvt_pk_bf16_f32 v80, v86, v87
    v_cvt_pk_bf16_f32 v81, v88, v89
    v_mul_f32 v86, v70, v76
    v_mul_f32 v87, v71, v76
    v_mul_f32 v88, v72, v76
    v_mul_f32 v89, v73, v76
    v_cvt_pk_bf16_f32 v82, v86, v87
    v_cvt_pk_bf16_f32 v83, v88, v89
    v_bfe_u32 v77, v107, 16, 14
    v_mul_u32_u24 v77, s49, v77
    v_lshrrev_b32 v84, 30, v107
    v_lshlrev_b32 v84, 6, v84
    v_lshl_add_u32 v84, v66, 11, v84
    v_lshlrev_b32 v66, 6, v66
    s_waitcnt lgkmcnt(0)
    v_cmp_lt_u32 vcc, 63, v67
    v_and_b32 v68, 3, v67
    v_bfe_u32 v69, v67, 2, 3
    v_lshl_or_b32 v85, v68, 3, v69
    v_and_or_b32 v85, v67, 32, v85
    s_or_b64 s[60:61], s[60:61], vcc
    s_andn2_b64 exec, exec, vcc
    v_lshl_add_u32 v66, v85, 2, v66
    ds_write_b32 v66, v77 offset:0
    v_lshrrev_b32 v68, 3, v85
    v_lshl_add_u32 v68, v68, 8, v84
    v_lshl_add_u32 v68, v69, 1, v68
    ds_write_b16 v68, v104 offset:8768
    ds_write_b16_d16_hi v68, v104 offset:8784
    ds_write_b16 v68, v105 offset:8800
    ds_write_b16_d16_hi v68, v105 offset:8816
    ds_write_b16 v68, v78 offset:10816
    ds_write_b16_d16_hi v68, v78 offset:10832
    ds_write_b16 v68, v79 offset:10848
    ds_write_b16_d16_hi v68, v79 offset:10864
    ds_write_b16 v68, v80 offset:12864
    ds_write_b16_d16_hi v68, v80 offset:12880
    ds_write_b16 v68, v81 offset:12896
    ds_write_b16_d16_hi v68, v81 offset:12912
    ds_write_b16 v68, v82 offset:14912
    ds_write_b16_d16_hi v68, v82 offset:14928
    ds_write_b16 v68, v83 offset:14944
    ds_write_b16_d16_hi v68, v83 offset:14960
K2_S0A:
    s_andn2_b64 exec, s[62:63], s[60:61]
    v_add_u32 v100, 1, v100
    s_branch K2_S0L
K2_S0Q:
    s_mov_b64 exec, -1
    v_add_u32 v114, 2621440, v103
    s_mov_b64 exec, s[52:53]
    s_cbranch_execz K2_S1Q
    buffer_load_dwordx4 v[104:107], v114, s[32:35], 0 offen sc1
    v_lshrrev_b32 v1, 3, v0
    v_add_u32 v112, 80, v1
    v_mul_u32_u24 v112, 2560, v112
    s_mov_b64 s[60:61], 0
    s_waitcnt vmcnt(0)
    v_bfe_u32 v1, v107, 16, 14
    v_cmp_eq_u32 vcc, s45, v1
    v_add_lshl_u32 v112, v112, v104, 4
    v_add_u32 v112, 0x600000, v112
    v_cndmask_b32 v112, v114, v112, vcc
    v_cndmask_b32 v113, 1, v105, vcc
    v_min_u32 v113, 2560, v113
K2_S1L:
    s_mov_b64 exec, s[52:53]
    v_and_b32 v1, 0xffff, v101
    v_cmp_lt_u32 vcc, v1, v113
    v_lshl_add_u32 v114, v1, 4, v112
    v_lshrrev_b32 v115, 16, v101
    v_min_u32 v1, 31, v1
    v_bfe_u32 v115, v115, v1, 1
    s_mov_b64 s[52:53], vcc
    s_andn2_b64 exec, vcc, s[60:61]
    s_cbranch_execz K2_S1Q
    buffer_load_dwordx4 v[104:107], v114, s[32:35], 0 offen sc1
    s_mov_b64 s[62:63], exec
    v_cmp_eq_u32 s[54:55], 0, v115
    s_waitcnt vmcnt(0)
    v_bfe_u32 v1, v107, 16, 14
    v_cmp_gt_u32 vcc, s44, v1
    s_and_b64 exec, exec, s[54:55]
    s_and_b64 exec, exec, vcc
    s_cbranch_execz K2_S1A
    v_bfe_u32 v66, v106, 14, 1
    v_bfe_u32 v68, v106, 30, 1
    v_lshlrev_b32 v66, 2, v66
    v_lshl_or_b32 v66, v68, 3, v66
    v_bfe_u32 v68, v107, 14, 1
    v_lshl_or_b32 v66, v68, 4, v66
    v_bfe_u32 v68, v0, 2, 1
    v_mad_u32_u24 v66, v68, 20, v66
    ds_add_rtn_u32 v67, v66, v60 offset:8704
    v_lshlrev_b32 v70, 16, v104
    v_and_b32 v71, 0xffff0000, v104
    v_lshlrev_b32 v72, 16, v105
    v_and_b32 v73, 0xffff0000, v105
    v_and_b32 v74, 0xbfff, v106
    v_lshlrev_b32 v74, 16, v74
    v_and_b32 v75, 0xbfff0000, v106
    v_and_b32 v76, 0xbfff, v107
    v_lshlrev_b32 v76, 16, v76
    v_mul_f32 v86, v70, v74
    v_mul_f32 v87, v71, v74
    v_mul_f32 v88, v72, v74
    v_mul_f32 v89, v73, v74
    v_cvt_pk_bf16_f32 v78, v86, v87
    v_cvt_pk_bf16_f32 v79, v88, v89
    v_mul_f32 v86, v70, v75
    v_mul_f32 v87, v71, v75
    v_mul_f32 v88, v72, v75
    v_mul_f32 v89, v73, v75
    v_cvt_pk_bf16_f32 v80, v86, v87
    v_cvt_pk_bf16_f32 v81, v88, v89
    v_mul_f32 v86, v70, v76
    v_mul_f32 v87, v71, v76
    v_mul_f32 v88, v72, v76
    v_mul_f32 v89, v73, v76
    v_cvt_pk_bf16_f32 v82, v86, v87
    v_cvt_pk_bf16_f32 v83, v88, v89
    v_bfe_u32 v77, v107, 16, 14
    v_mul_u32_u24 v77, s49, v77
    v_lshrrev_b32 v84, 30, v107
    v_lshlrev_b32 v84, 6, v84
    v_lshl_add_u32 v84, v66, 11, v84
    v_lshlrev_b32 v66, 6, v66
    s_waitcnt lgkmcnt(0)
    v_cmp_lt_u32 vcc, 63, v67
    v_and_b32 v68, 3, v67
    v_bfe_u32 v69, v67, 2, 3
    v_lshl_or_b32 v85, v68, 3, v69
    v_and_or_b32 v85, v67, 32, v85
    s_or_b64 s[60:61], s[60:61], vcc
    s_andn2_b64 exec, exec, vcc
    v_lshl_add_u32 v66, v85, 2, v66
    ds_write_b32 v66, v77 offset:0
    v_lshrrev_b32 v68, 3, v85
    v_lshl_add_u32 v68, v68, 8, v84
    v_lshl_add_u32 v68, v69, 1, v68
    ds_write_b16 v68, v104 offset:8768
    ds_write_b16_d16_hi v68, v104 offset:8784
    ds_write_b16 v68, v105 offset:8800
    ds_write_b16_d16_hi v68, v105 offset:8816
    ds_write_b16 v68, v78 offset:10816
    ds_write_b16_d16_hi v68, v78 offset:10832
    ds_write_b16 v68, v79 offset:10848
    ds_write_b16_d16_hi v68, v79 offset:10864
    ds_write_b16 v68, v80 offset:12864
    ds_write_b16_d16_hi v68, v80 offset:12880
    ds_write_b16 v68, v81 offset:12896
    ds_write_b16_d16_hi v68, v81 offset:12912
    ds_write_b16 v68, v82 offset:14912
    ds_write_b16_d16_hi v68, v82 offset:14928
    ds_write_b16 v68, v83 offset:14944
    ds_write_b16_d16_hi v68, v83 offset:14960
K2_S1A:
    s_andn2_b64 exec, s[62:63], s[60:61]
    v_add_u32 v101, 1, v101
    s_branch K2_S1L
K2_S1Q:
    s_mov_b64 exec, -1
    s_or_b64 s[54:55], s[50:51], s[52:53]
    s_cmp_eq_u64 s[54:55], 0
    s_cbranch_scc1 K2_NOFLAG
    v_mov_b32 v1, 0
    ds_write_b32 v1, v60 offset:8748
K2_NOFLAG:
    s_cmp_lg_u32 s3, 8
    s_cbranch_scc1 PB_N9B
    s_mov_b32 s66, 0
    v_mov_b32 v88, 0
PB_PM:
    buffer_load_dword v89, v88, s[68:71], 0 offen offset:132 sc1
    s_add_u32 s66, s66, 1
    s_waitcnt vmcnt(0)
    v_readfirstlane_b32 s67, v89
    s_cmp_lg_u32 s67, 0
    s_cbranch_scc1 PB_PM_D
    s_cmp_lt_u32 s66, 0x40000
    s_sleep 1
    s_cbranch_scc1 PB_PM
PB_PM_D:
PB_N9B:
    v_bfe_u32 v68, v0, 4, 2
    s_lshl_b32 s14, s3, 8
    v_lshl_add_u32 v102, v68, 5, s14
    s_lshl_b32 s14, s3, 2
    v_mov_b32 v69, s14
    v_mov_b32 v70, 0
    v_and_b32 v1, 63, v0
    s_lshl_b32 s14, s3, 13
    v_lshl_add_u32 v1, v1, 4, s14
    s_waitcnt lgkmcnt(0)
    s_barrier
    ds_read_b32 v66, v69 offset:8704
    ds_read_b32 v67, v70 offset:8748
    ds_read_b128 v[50:53], v102 offset:0
    ds_read_b128 v[54:57], v102 offset:16
    s_waitcnt lgkmcnt(2)
    v_readfirstlane_b32 s54, v66
    v_readfirstlane_b32 s55, v67
    s_min_u32 s54, s54, 64
    s_cmp_le_u32 s54, 32
    s_cbranch_scc1 K2_NOPRI
    s_setprio 3
K2_NOPRI:
K2_KSTEP:
    s_cmp_eq_u32 s54, 0
    s_cbranch_scc1 K2_KDONE
    ds_read_b128 v[34:37], v1 offset:8768
    ds_read_b128 v[38:41], v1 offset:10816
    ds_read_b128 v[42:45], v1 offset:12864
    ds_read_b128 v[46:49], v1 offset:14912
    s_waitcnt lgkmcnt(4)
    v_add_u32 v50, v50, v98
    v_add_u32 v51, v51, v98
    v_add_u32 v52, v52, v98
    v_add_u32 v53, v53, v98
    v_add_u32 v54, v54, v98
    v_add_u32 v55, v55, v98
    v_add_u32 v56, v56, v98
    v_add_u32 v57, v57, v98
    v_mov_b32 v58, 0
    v_mov_b32 v59, 0
    v_mov_b32 v60, 0
    v_mov_b32 v61, 0
    v_mov_b32 v62, 0
    v_mov_b32 v63, 0
    v_mov_b32 v64, 0
    v_mov_b32 v65, 0
    s_cmp_le_u32 s54, 8
    s_cbranch_scc1 K2_V1
    s_cmp_le_u32 s54, 16
    s_cbranch_scc1 K2_V2
    s_cmp_le_u32 s54, 24
    s_cbranch_scc1 K2_V3
K2_V4:
    buffer_load_dwordx4 v[104:107], v50, s[28:31], 0 offen offset:1024 sc1
    buffer_load_dwordx4 v[108:111], v51, s[28:31], 0 offen offset:1024 sc1
    buffer_load_dwordx4 v[112:115], v52, s[28:31], 0 offen offset:1024 sc1
    buffer_load_dwordx4 v[116:119], v53, s[28:31], 0 offen offset:1024 sc1
    buffer_load_dwordx4 v[120:123], v54, s[28:31], 0 offen offset:1024 sc1
    buffer_load_dwordx4 v[124:127], v55, s[28:31], 0 offen offset:1024 sc1
    buffer_load_dwordx4 v[128:131], v56, s[28:31], 0 offen offset:1024 sc1
    buffer_load_dwordx4 v[132:135], v57, s[28:31], 0 offen offset:1024 sc1
    buffer_load_dwordx4 v[136:139], v50, s[28:31], 0 offen offset:0 sc1
    buffer_load_dwordx4 v[140:143], v51, s[28:31], 0 offen offset:0 sc1
    buffer_load_dwordx4 v[144:147], v52, s[28:31], 0 offen offset:0 sc1
    buffer_load_dwordx4 v[148:151], v53, s[28:31], 0 offen offset:0 sc1
    buffer_load_dwordx4 v[152:155], v54, s[28:31], 0 offen offset:0 sc1
    buffer_load_dwordx4 v[156:159], v55, s[28:31], 0 offen offset:0 sc1
    buffer_load_dwordx4 v[160:163], v56, s[28:31], 0 offen offset:0 sc1
    buffer_load_dwordx4 v[164:167], v57, s[28:31], 0 offen offset:0 sc1
    s_cmp_lg_u32 s57, 0
    s_cbranch_scc1 K2_V4_GO
    s_waitcnt vmcnt(16)
    v_lshlrev_b32 v2, 16, v18
    v_and_b32 v3, 0xffff0000, v18
    v_lshlrev_b32 v4, 16, v19
    v_and_b32 v5, 0xffff0000, v19
    v_lshlrev_b32 v6, 16, v20
    v_and_b32 v7, 0xffff0000, v20
    v_lshlrev_b32 v8, 16, v21
    v_and_b32 v9, 0xffff0000, v21
    v_lshlrev_b32 v10, 16, v22
    v_and_b32 v11, 0xffff0000, v22
    v_lshlrev_b32 v12, 16, v23
    v_and_b32 v13, 0xffff0000, v23
    v_lshlrev_b32 v14, 16, v24
    v_and_b32 v15, 0xffff0000, v24
    v_lshlrev_b32 v16, 16, v25
    v_and_b32 v17, 0xffff0000, v25
    v_lshlrev_b32 v18, 16, v26
    v_and_b32 v19, 0xffff0000, v26
    v_lshlrev_b32 v20, 16, v27
    v_and_b32 v21, 0xffff0000, v27
    v_lshlrev_b32 v22, 16, v28
    v_and_b32 v23, 0xffff0000, v28
    v_lshlrev_b32 v24, 16, v29
    v_and_b32 v25, 0xffff0000, v29
    v_lshlrev_b32 v26, 16, v30
    v_and_b32 v27, 0xffff0000, v30
    v_lshlrev_b32 v28, 16, v31
    v_and_b32 v29, 0xffff0000, v31
    v_lshlrev_b32 v30, 16, v32
    v_and_b32 v31, 0xffff0000, v32
    v_lshlrev_b32 v32, 16, v33
    v_and_b32 v33, 0xffff0000, v33
    s_mov_b32 s57, 1
K2_V4_GO:
    ds_read_b128 v[90:93], v98 offset:6656
    ds_read_b128 v[94:97], v98 offset:6912
    s_waitcnt vmcnt(8)
    v_perm_b32 v58, v108, v104, s46
    v_perm_b32 v59, v116, v112, s46
    v_perm_b32 v60, v124, v120, s46
    v_perm_b32 v61, v132, v128, s46
    s_waitcnt lgkmcnt(2)
    s_nop 0
    v_mfma_f32_16x16x32_bf16 v[66:69], v[38:41], v[58:61], 0
    v_mfma_f32_16x16x32_bf16 v[70:73], v[42:45], v[58:61], 0
    v_mfma_f32_16x16x32_bf16 v[74:77], v[46:49], v[58:61], 0
    v_perm_b32 v62, v108, v104, s47
    v_perm_b32 v63, v116, v112, s47
    v_perm_b32 v64, v124, v120, s47
    v_perm_b32 v65, v132, v128, s47
    s_nop 1
    v_mfma_f32_16x16x32_bf16 v[78:81], v[38:41], v[62:65], 0
    v_mfma_f32_16x16x32_bf16 v[82:85], v[42:45], v[62:65], 0
    v_mfma_f32_16x16x32_bf16 v[86:89], v[46:49], v[62:65], 0
    v_perm_b32 v58, v109, v105, s46
    v_perm_b32 v59, v117, v113, s46
    v_perm_b32 v60, v125, v121, s46
    v_perm_b32 v61, v133, v129, s46
    s_waitcnt lgkmcnt(1)
    v_fmac_f32 v10, v90, v66
    v_fmac_f32 v18, v90, v70
    v_fmac_f32 v26, v90, v74
    v_fmac_f32 v10, v91, v67
    v_fmac_f32 v18, v91, v71
    v_fmac_f32 v26, v91, v75
    v_fmac_f32 v10, v92, v68
    v_fmac_f32 v18, v92, v72
    v_fmac_f32 v26, v92, v76
    v_fmac_f32 v10, v93, v69
    v_fmac_f32 v18, v93, v73
    v_fmac_f32 v26, v93, v77
    ds_read_b128 v[90:93], v98 offset:7168
    v_mfma_f32_16x16x32_bf16 v[66:69], v[38:41], v[58:61], 0
    v_mfma_f32_16x16x32_bf16 v[70:73], v[42:45], v[58:61], 0
    v_mfma_f32_16x16x32_bf16 v[74:77], v[46:49], v[58:61], 0
    v_perm_b32 v62, v109, v105, s47
    v_perm_b32 v63, v117, v113, s47
    v_perm_b32 v64, v125, v121, s47
    v_perm_b32 v65, v133, v129, s47
    s_waitcnt lgkmcnt(1)
    v_fmac_f32 v11, v94, v78
    v_fmac_f32 v19, v94, v82
    v_fmac_f32 v27, v94, v86
    v_fmac_f32 v11, v95, v79
    v_fmac_f32 v19, v95, v83
    v_fmac_f32 v27, v95, v87
    v_fmac_f32 v11, v96, v80
    v_fmac_f32 v19, v96, v84
    v_fmac_f32 v27, v96, v88
    v_fmac_f32 v11, v97, v81
    v_fmac_f32 v19, v97, v85
    v_fmac_f32 v27, v97, v89
    ds_read_b128 v[94:97], v98 offset:7424
    v_mfma_f32_16x16x32_bf16 v[78:81], v[38:41], v[62:65], 0
    v_mfma_f32_16x16x32_bf16 v[82:85], v[42:45], v[62:65], 0
    v_mfma_f32_16x16x32_bf16 v[86:89], v[46:49], v[62:65], 0
    v_perm_b32 v58, v110, v106, s46
    v_perm_b32 v59, v118, v114, s46
    v_perm_b32 v60, v126, v122, s46
    v_perm_b32 v61, v134, v130, s46
    s_waitcnt lgkmcnt(1)
    v_fmac_f32 v12, v90, v66
    v_fmac_f32 v20, v90, v70
    v_fmac_f32 v28, v90, v74
    v_fmac_f32 v12, v91, v67
    v_fmac_f32 v20, v91, v71
    v_fmac_f32 v28, v91, v75
    v_fmac_f32 v12, v92, v68
    v_fmac_f32 v20, v92, v72
    v_fmac_f32 v28, v92, v76
    v_fmac_f32 v12, v93, v69
    v_fmac_f32 v20, v93, v73
    v_fmac_f32 v28, v93, v77
    ds_read_b128 v[90:93], v98 offset:7680
    v_mfma_f32_16x16x32_bf16 v[66:69], v[38:41], v[58:61], 0
    v_mfma_f32_16x16x32_bf16 v[70:73], v[42:45], v[58:61], 0
    v_mfma_f32_16x16x32_bf16 v[74:77], v[46:49], v[58:61], 0
    v_perm_b32 v62, v110, v106, s47
    v_perm_b32 v63, v118, v114, s47
    v_perm_b32 v64, v126, v122, s47
    v_perm_b32 v65, v134, v130, s47
    s_waitcnt lgkmcnt(1)
    v_fmac_f32 v13, v94, v78
    v_fmac_f32 v21, v94, v82
    v_fmac_f32 v29, v94, v86
    v_fmac_f32 v13, v95, v79
    v_fmac_f32 v21, v95, v83
    v_fmac_f32 v29, v95, v87
    v_fmac_f32 v13, v96, v80
    v_fmac_f32 v21, v96, v84
    v_fmac_f32 v29, v96, v88
    v_fmac_f32 v13, v97, v81
    v_fmac_f32 v21, v97, v85
    v_fmac_f32 v29, v97, v89
    ds_read_b128 v[94:97], v98 offset:7936
    v_mfma_f32_16x16x32_bf16 v[78:81], v[38:41], v[62:65], 0
    v_mfma_f32_16x16x32_bf16 v[82:85], v[42:45], v[62:65], 0
    v_mfma_f32_16x16x32_bf16 v[86:89], v[46:49], v[62:65], 0
    v_perm_b32 v58, v111, v107, s46
    v_perm_b32 v59, v119, v115, s46
    v_perm_b32 v60, v127, v123, s46
    v_perm_b32 v61, v135, v131, s46
    s_waitcnt lgkmcnt(1)
    v_fmac_f32 v14, v90, v66
    v_fmac_f32 v22, v90, v70
    v_fmac_f32 v30, v90, v74
    v_fmac_f32 v14, v91, v67
    v_fmac_f32 v22, v91, v71
    v_fmac_f32 v30, v91, v75
    v_fmac_f32 v14, v92, v68
    v_fmac_f32 v22, v92, v72
    v_fmac_f32 v30, v92, v76
    v_fmac_f32 v14, v93, v69
    v_fmac_f32 v22, v93, v73
    v_fmac_f32 v30, v93, v77
    ds_read_b128 v[90:93], v98 offset:8192
    v_mfma_f32_16x16x32_bf16 v[66:69], v[38:41], v[58:61], 0
    v_mfma_f32_16x16x32_bf16 v[70:73], v[42:45], v[58:61], 0
    v_mfma_f32_16x16x32_bf16 v[74:77], v[46:49], v[58:61], 0
    v_perm_b32 v62, v111, v107, s47
    v_perm_b32 v63, v119, v115, s47
    v_perm_b32 v64, v127, v123, s47
    v_perm_b32 v65, v135, v131, s47
    buffer_load_dwordx4 v[104:107], v50, s[28:31], 0 offen offset:256 sc1
    buffer_load_dwordx4 v[108:111], v51, s[28:31], 0 offen offset:256 sc1
    buffer_load_dwordx4 v[112:115], v52, s[28:31], 0 offen offset:256 sc1
    buffer_load_dwordx4 v[116:119], v53, s[28:31], 0 offen offset:256 sc1
    buffer_load_dwordx4 v[120:123], v54, s[28:31], 0 offen offset:256 sc1
    buffer_load_dwordx4 v[124:127], v55, s[28:31], 0 offen offset:256 sc1
    buffer_load_dwordx4 v[128:131], v56, s[28:31], 0 offen offset:256 sc1
    buffer_load_dwordx4 v[132:135], v57, s[28:31], 0 offen offset:256 sc1
    s_waitcnt lgkmcnt(1)
    v_fmac_f32 v15, v94, v78
    v_fmac_f32 v23, v94, v82
    v_fmac_f32 v31, v94, v86
    v_fmac_f32 v15, v95, v79
    v_fmac_f32 v23, v95, v83
    v_fmac_f32 v31, v95, v87
    v_fmac_f32 v15, v96, v80
    v_fmac_f32 v23, v96, v84
    v_fmac_f32 v31, v96, v88
    v_fmac_f32 v15, v97, v81
    v_fmac_f32 v23, v97, v85
    v_fmac_f32 v31, v97, v89
    ds_read_b128 v[94:97], v98 offset:8448
    v_mfma_f32_16x16x32_bf16 v[78:81], v[38:41], v[62:65], 0
    v_mfma_f32_16x16x32_bf16 v[82:85], v[42:45], v[62:65], 0
    v_mfma_f32_16x16x32_bf16 v[86:89], v[46:49], v[62:65], 0
    s_waitcnt vmcnt(8)
    v_perm_b32 v58, v140, v136, s46
    v_perm_b32 v59, v148, v144, s46
    v_perm_b32 v60, v156, v152, s46
    v_perm_b32 v61, v164, v160, s46
    s_waitcnt lgkmcnt(1)
    v_fmac_f32 v16, v90, v66
    v_fmac_f32 v24, v90, v70
    v_fmac_f32 v32, v90, v74
    v_fmac_f32 v16, v91, v67
    v_fmac_f32 v24, v91, v71
    v_fmac_f32 v32, v91, v75
    v_fmac_f32 v16, v92, v68
    v_fmac_f32 v24, v92, v72
    v_fmac_f32 v32, v92, v76
    v_fmac_f32 v16, v93, v69
    v_fmac_f32 v24, v93, v73
    v_fmac_f32 v32, v93, v77
    ds_read_b128 v[90:93], v98 offset:2560
    v_mfma_f32_16x16x32_bf16 v[74:77], v[34:37], v[58:61], 0
    v_perm_b32 v62, v140, v136, s47
    v_perm_b32 v63, v148, v144, s47
    v_perm_b32 v64, v156, v152, s47
    v_perm_b32 v65, v164, v160, s47
    s_waitcnt lgkmcnt(1)
    v_fmac_f32 v17, v94, v78
    v_fmac_f32 v25, v94, v82
    v_fmac_f32 v33, v94, v86
    v_fmac_f32 v17, v95, v79
    v_fmac_f32 v25, v95, v83
    v_fmac_f32 v33, v95, v87
    v_fmac_f32 v17, v96, v80
    v_fmac_f32 v25, v96, v84
    v_fmac_f32 v33, v96, v88
    v_fmac_f32 v17, v97, v81
    v_fmac_f32 v25, v97, v85
    v_fmac_f32 v33, v97, v89
    ds_read_b128 v[94:97], v98 offset:2816
    buffer_load_dwordx4 v[38:41], v50, s[28:31], 0 offen offset:512 sc1
    buffer_load_dwordx4 v[42:45], v51, s[28:31], 0 offen offset:512 sc1
    buffer_load_dwordx4 v[46:49], v52, s[28:31], 0 offen offset:512 sc1
    buffer_load_dwordx4 v[78:81], v53, s[28:31], 0 offen offset:512 sc1
    buffer_load_dwordx4 v[82:85], v54, s[28:31], 0 offen offset:512 sc1
    buffer_load_dwordx4 v[86:89], v55, s[28:31], 0 offen offset:512 sc1
    v_mfma_f32_16x16x32_bf16 v[66:69], v[34:37], v[62:65], 0
    v_perm_b32 v58, v141, v137, s46
    v_perm_b32 v59, v149, v145, s46
    v_perm_b32 v60, v157, v153, s46
    v_perm_b32 v61, v165, v161, s46
    s_waitcnt lgkmcnt(1)
    v_fmac_f32 v2, v90, v74
    v_fmac_f32 v2, v91, v75
    v_fmac_f32 v2, v92, v76
    v_fmac_f32 v2, v93, v77
    ds_read_b128 v[90:93], v98 offset:3072
    v_mfma_f32_16x16x32_bf16 v[70:73], v[34:37], v[58:61], 0
    v_perm_b32 v62, v141, v137, s47
    v_perm_b32 v63, v149, v145, s47
    v_perm_b32 v64, v157, v153, s47
    v_perm_b32 v65, v165, v161, s47
    s_waitcnt lgkmcnt(1)
    v_fmac_f32 v3, v94, v66
    v_fmac_f32 v3, v95, v67
    v_fmac_f32 v3, v96, v68
    v_fmac_f32 v3, v97, v69
    ds_read_b128 v[94:97], v98 offset:3328
    v_mfma_f32_16x16x32_bf16 v[74:77], v[34:37], v[62:65], 0
    v_perm_b32 v58, v142, v138, s46
    v_perm_b32 v59, v150, v146, s46
    v_perm_b32 v60, v158, v154, s46
    v_perm_b32 v61, v166, v162, s46
    s_waitcnt lgkmcnt(1)
    v_fmac_f32 v4, v90, v70
    v_fmac_f32 v4, v91, v71
    v_fmac_f32 v4, v92, v72
    v_fmac_f32 v4, v93, v73
    ds_read_b128 v[90:93], v98 offset:3584
    v_mfma_f32_16x16x32_bf16 v[66:69], v[34:37], v[58:61], 0
    v_perm_b32 v62, v142, v138, s47
    v_perm_b32 v63, v150, v146, s47
    v_perm_b32 v64, v158, v154, s47
    v_perm_b32 v65, v166, v162, s47
    s_waitcnt lgkmcnt(1)
    v_fmac_f32 v5, v94, v74
    v_fmac_f32 v5, v95, v75
    v_fmac_f32 v5, v96, v76
    v_fmac_f32 v5, v97, v77
    ds_read_b128 v[94:97], v98 offset:3840
    v_mfma_f32_16x16x32_bf16 v[70:73], v[34:37], v[62:65], 0
    v_perm_b32 v58, v143, v139, s46
    v_perm_b32 v59, v151, v147, s46
    v_perm_b32 v60, v159, v155, s46
    v_perm_b32 v61, v167, v163, s46
    s_waitcnt lgkmcnt(1)
    v_fmac_f32 v6, v90, v66
    v_fmac_f32 v6, v91, v67
    v_fmac_f32 v6, v92, v68
    v_fmac_f32 v6, v93, v69
    ds_read_b128 v[90:93], v98 offset:4096
    v_mfma_f32_16x16x32_bf16 v[74:77], v[34:37], v[58:61], 0
    v_perm_b32 v62, v143, v139, s47
    v_perm_b32 v63, v151, v147, s47
    v_perm_b32 v64, v159, v155, s47
    v_perm_b32 v65, v167, v163, s47
    buffer_load_dwordx4 v[136:139], v56, s[28:31], 0 offen offset:512 sc1
    buffer_load_dwordx4 v[140:143], v57, s[28:31], 0 offen offset:512 sc1
    buffer_load_dwordx4 v[144:147], v50, s[28:31], 0 offen offset:768 sc1
    buffer_load_dwordx4 v[148:151], v51, s[28:31], 0 offen offset:768 sc1
    buffer_load_dwordx4 v[152:155], v52, s[28:31], 0 offen offset:768 sc1
    buffer_load_dwordx4 v[156:159], v53, s[28:31], 0 offen offset:768 sc1
    buffer_load_dwordx4 v[160:163], v54, s[28:31], 0 offen offset:768 sc1
    buffer_load_dwordx4 v[164:167], v55, s[28:31], 0 offen offset:768 sc1
    s_waitcnt lgkmcnt(1)
    v_fmac_f32 v7, v94, v70
    v_fmac_f32 v7, v95, v71
    v_fmac_f32 v7, v96, v72
    v_fmac_f32 v7, v97, v73
    ds_read_b128 v[94:97], v98 offset:4352
    v_mfma_f32_16x16x32_bf16 v[66:69], v[34:37], v[62:65], 0
    s_waitcnt vmcnt(14)
    v_perm_b32 v58, v108, v104, s46
    v_perm_b32 v59, v116, v112, s46
    v_perm_b32 v60, v124, v120, s46
    v_perm_b32 v61, v132, v128, s46
    s_waitcnt lgkmcnt(1)
    v_fmac_f32 v8, v90, v74
    v_fmac_f32 v8, v91, v75
    v_fmac_f32 v8, v92, v76
    v_fmac_f32 v8, v93, v77
    ds_read_b128 v[90:93], v98 offset:4608
    v_mfma_f32_16x16x32_bf16 v[70:73], v[34:37], v[58:61], 0
    v_perm_b32 v62, v108, v104, s47
    v_perm_b32 v63, v116, v112, s47
    v_perm_b32 v64, v124, v120, s47
    v_perm_b32 v65, v132, v128, s47
    s_waitcnt lgkmcnt(1)
    v_fmac_f32 v9, v94, v66
    v_fmac_f32 v9, v95, v67
    v_fmac_f32 v9, v96, v68
    v_fmac_f32 v9, v97, v69
    ds_read_b128 v[94:97], v98 offset:4864
    v_mfma_f32_16x16x32_bf16 v[74:77], v[34:37], v[62:65], 0
    v_perm_b32 v58, v109, v105, s46
    v_perm_b32 v59, v117, v113, s46
    v_perm_b32 v60, v125, v121, s46
    v_perm_b32 v61, v133, v129, s46
    s_waitcnt lgkmcnt(1)
    v_fmac_f32 v10, v90, v70
    v_fmac_f32 v10, v91, v71
    v_fmac_f32 v10, v92, v72
    v_fmac_f32 v10, v93, v73
    ds_read_b128 v[90:93], v98 offset:5120
    v_mfma_f32_16x16x32_bf16 v[66:69], v[34:37], v[58:61], 0
    v_perm_b32 v62, v109, v105, s47
    v_perm_b32 v63, v117, v113, s47
    v_perm_b32 v64, v125, v121, s47
    v_perm_b32 v65, v133, v129, s47
    s_waitcnt lgkmcnt(1)
    v_fmac_f32 v11, v94, v74
    v_fmac_f32 v11, v95, v75
    v_fmac_f32 v11, v96, v76
    v_fmac_f32 v11, v97, v77
    ds_read_b128 v[94:97], v98 offset:5376
    v_mfma_f32_16x16x32_bf16 v[70:73], v[34:37], v[62:65], 0
    v_perm_b32 v58, v110, v106, s46
    v_perm_b32 v59, v118, v114, s46
    v_perm_b32 v60, v126, v122, s46
    v_perm_b32 v61, v134, v130, s46
    s_waitcnt lgkmcnt(1)
    v_fmac_f32 v12, v90, v66
    v_fmac_f32 v12, v91, v67
    v_fmac_f32 v12, v92, v68
    v_fmac_f32 v12, v93, v69
    ds_read_b128 v[90:93], v98 offset:5632
    v_mfma_f32_16x16x32_bf16 v[74:77], v[34:37], v[58:61], 0
    v_perm_b32 v62, v110, v106, s47
    v_perm_b32 v63, v118, v114, s47
    v_perm_b32 v64, v126, v122, s47
    v_perm_b32 v65, v134, v130, s47
    s_waitcnt lgkmcnt(1)
    v_fmac_f32 v13, v94, v70
    v_fmac_f32 v13, v95, v71
    v_fmac_f32 v13, v96, v72
    v_fmac_f32 v13, v97, v73
    ds_read_b128 v[94:97], v98 offset:5888
    v_mfma_f32_16x16x32_bf16 v[66:69], v[34:37], v[62:65], 0
    v_perm_b32 v58, v111, v107, s46
    v_perm_b32 v59, v119, v115, s46
    v_perm_b32 v60, v127, v123, s46
    v_perm_b32 v61, v135, v131, s46
    s_waitcnt lgkmcnt(1)
    v_fmac_f32 v14, v90, v74
    v_fmac_f32 v14, v91, v75
    v_fmac_f32 v14, v92, v76
    v_fmac_f32 v14, v93, v77
    ds_read_b128 v[90:93], v98 offset:6144
    v_mfma_f32_16x16x32_bf16 v[70:73], v[34:37], v[58:61], 0
    v_perm_b32 v62, v111, v107, s47
    v_perm_b32 v63, v119, v115, s47
    v_perm_b32 v64, v127, v123, s47
    v_perm_b32 v65, v135, v131, s47
    buffer_load_dwordx4 v[104:107], v56, s[28:31], 0 offen offset:768 sc1
    buffer_load_dwordx4 v[108:111], v57, s[28:31], 0 offen offset:768 sc1
    s_waitcnt lgkmcnt(1)
    v_fmac_f32 v15, v94, v66
    v_fmac_f32 v15, v95, v67
    v_fmac_f32 v15, v96, v68
    v_fmac_f32 v15, v97, v69
    ds_read_b128 v[94:97], v98 offset:6400
    v_mfma_f32_16x16x32_bf16 v[74:77], v[34:37], v[62:65], 0
    s_waitcnt vmcnt(8)
    v_perm_b32 v58, v42, v38, s46
    v_perm_b32 v59, v78, v46, s46
    v_perm_b32 v60, v86, v82, s46
    v_perm_b32 v61, v140, v136, s46
    s_waitcnt lgkmcnt(1)
    v_fmac_f32 v16, v90, v70
    v_fmac_f32 v16, v91, v71
    v_fmac_f32 v16, v92, v72
    v_fmac_f32 v16, v93, v73
    ds_read_b128 v[90:93], v98 offset:4608
    v_mfma_f32_16x16x32_bf16 v[66:69], v[34:37], v[58:61], 0
    v_perm_b32 v62, v42, v38, s47
    v_perm_b32 v63, v78, v46, s47
    v_perm_b32 v64, v86, v82, s47
    v_perm_b32 v65, v140, v136, s47
    s_waitcnt lgkmcnt(1)
    v_fmac_f32 v17, v94, v74
    v_fmac_f32 v17, v95, v75
    v_fmac_f32 v17, v96, v76
    v_fmac_f32 v17, v97, v77
    ds_read_b128 v[94:97], v98 offset:4864
    v_mfma_f32_16x16x32_bf16 v[70:73], v[34:37], v[62:65], 0
    v_perm_b32 v58, v43, v39, s46
    v_perm_b32 v59, v79, v47, s46
    v_perm_b32 v60, v87, v83, s46
    v_perm_b32 v61, v141, v137, s46
    s_waitcnt lgkmcnt(1)
    v_fmac_f32 v18, v90, v66
    v_fmac_f32 v18, v91, v67
    v_fmac_f32 v18, v92, v68
    v_fmac_f32 v18, v93, v69
    ds_read_b128 v[90:93], v98 offset:5120
    v_mfma_f32_16x16x32_bf16 v[74:77], v[34:37], v[58:61], 0
    v_perm_b32 v62, v43, v39, s47
    v_perm_b32 v63, v79, v47, s47
    v_perm_b32 v64, v87, v83, s47
    v_perm_b32 v65, v141, v137, s47
    s_waitcnt lgkmcnt(1)
    v_fmac_f32 v19, v94, v70
    v_fmac_f32 v19, v95, v71
    v_fmac_f32 v19, v96, v72
    v_fmac_f32 v19, v97, v73
    ds_read_b128 v[94:97], v98 offset:5376
    v_mfma_f32_16x16x32_bf16 v[66:69], v[34:37], v[62:65], 0
    v_perm_b32 v58, v44, v40, s46
    v_perm_b32 v59, v80, v48, s46
    v_perm_b32 v60, v88, v84, s46
    v_perm_b32 v61, v142, v138, s46
    s_waitcnt lgkmcnt(1)
    v_fmac_f32 v20, v90, v74
    v_fmac_f32 v20, v91, v75
    v_fmac_f32 v20, v92, v76
    v_fmac_f32 v20, v93, v77
    ds_read_b128 v[90:93], v98 offset:5632
    v_mfma_f32_16x16x32_bf16 v[70:73], v[34:37], v[58:61], 0
    v_perm_b32 v62, v44, v40, s47
    v_perm_b32 v63, v80, v48, s47
    v_perm_b32 v64, v88, v84, s47
    v_perm_b32 v65, v142, v138, s47
    s_waitcnt lgkmcnt(1)
    v_fmac_f32 v21, v94, v66
    v_fmac_f32 v21, v95, v67
    v_fmac_f32 v21, v96, v68
    v_fmac_f32 v21, v97, v69
    ds_read_b128 v[94:97], v98 offset:5888
    v_mfma_f32_16x16x32_bf16 v[74:77], v[34:37], v[62:65], 0
    v_perm_b32 v58, v45, v41, s46
    v_perm_b32 v59, v81, v49, s46
    v_perm_b32 v60, v89, v85, s46
    v_perm_b32 v61, v143, v139, s46
    s_waitcnt lgkmcnt(1)
    v_fmac_f32 v22, v90, v70
    v_fmac_f32 v22, v91, v71
    v_fmac_f32 v22, v92, v72
    v_fmac_f32 v22, v93, v73
    ds_read_b128 v[90:93], v98 offset:6144
    v_mfma_f32_16x16x32_bf16 v[66:69], v[34:37], v[58:61], 0
    v_perm_b32 v62, v45, v41, s47
    v_perm_b32 v63, v81, v49, s47
    v_perm_b32 v64, v89, v85, s47
    v_perm_b32 v65, v143, v139, s47
    s_waitcnt lgkmcnt(1)
    v_fmac_f32 v23, v94, v74
    v_fmac_f32 v23, v95, v75
    v_fmac_f32 v23, v96, v76
    v_fmac_f32 v23, v97, v77
    ds_read_b128 v[94:97], v98 offset:6400
    v_mfma_f32_16x16x32_bf16 v[70:73], v[34:37], v[62:65], 0
    s_waitcnt vmcnt(0)
    v_perm_b32 v58, v148, v144, s46
    v_perm_b32 v59, v156, v152, s46
    v_perm_b32 v60, v164, v160, s46
    v_perm_b32 v61, v108, v104, s46
    s_waitcnt lgkmcnt(1)
    v_fmac_f32 v24, v90, v66
    v_fmac_f32 v24, v91, v67
    v_fmac_f32 v24, v92, v68
    v_fmac_f32 v24, v93, v69
    ds_read_b128 v[90:93], v98 offset:4608
    v_mfma_f32_16x16x32_bf16 v[74:77], v[34:37], v[58:61], 0
    v_perm_b32 v62, v148, v144, s47
    v_perm_b32 v63, v156, v152, s47
    v_perm_b32 v64, v164, v160, s47
    v_perm_b32 v65, v108, v104, s47
    s_waitcnt lgkmcnt(1)
    v_fmac_f32 v25, v94, v70
    v_fmac_f32 v25, v95, v71
    v_fmac_f32 v25, v96, v72
    v_fmac_f32 v25, v97, v73
    ds_read_b128 v[94:97], v98 offset:4864
    v_mfma_f32_16x16x32_bf16 v[66:69], v[34:37], v[62:65], 0
    v_perm_b32 v58, v149, v145, s46
    v_perm_b32 v59, v157, v153, s46
    v_perm_b32 v60, v165, v161, s46
    v_perm_b32 v61, v109, v105, s46
    s_waitcnt lgkmcnt(1)
    v_fmac_f32 v26, v90, v74
    v_fmac_f32 v26, v91, v75
    v_fmac_f32 v26, v92, v76
    v_fmac_f32 v26, v93, v77
    ds_read_b128 v[90:93], v98 offset:5120
    v_mfma_f32_16x16x32_bf16 v[70:73], v[34:37], v[58:61], 0
    v_perm_b32 v62, v149, v145, s47
    v_perm_b32 v63, v157, v153, s47
    v_perm_b32 v64, v165, v161, s47
    v_perm_b32 v65, v109, v105, s47
    s_waitcnt lgkmcnt(1)
    v_fmac_f32 v27, v94, v66
    v_fmac_f32 v27, v95, v67
    v_fmac_f32 v27, v96, v68
    v_fmac_f32 v27, v97, v69
    ds_read_b128 v[94:97], v98 offset:5376
    v_mfma_f32_16x16x32_bf16 v[74:77], v[34:37], v[62:65], 0
    v_perm_b32 v58, v150, v146, s46
    v_perm_b32 v59, v158, v154, s46
    v_perm_b32 v60, v166, v162, s46
    v_perm_b32 v61, v110, v106, s46
    s_waitcnt lgkmcnt(1)
    v_fmac_f32 v28, v90, v70
    v_fmac_f32 v28, v91, v71
    v_fmac_f32 v28, v92, v72
    v_fmac_f32 v28, v93, v73
    ds_read_b128 v[90:93], v98 offset:5632
    v_mfma_f32_16x16x32_bf16 v[66:69], v[34:37], v[58:61], 0
    v_perm_b32 v62, v150, v146, s47
    v_perm_b32 v63, v158, v154, s47
    v_perm_b32 v64, v166, v162, s47
    v_perm_b32 v65, v110, v106, s47
    s_waitcnt lgkmcnt(1)
    v_fmac_f32 v29, v94, v74
    v_fmac_f32 v29, v95, v75
    v_fmac_f32 v29, v96, v76
    v_fmac_f32 v29, v97, v77
    ds_read_b128 v[94:97], v98 offset:5888
    v_mfma_f32_16x16x32_bf16 v[70:73], v[34:37], v[62:65], 0
    v_perm_b32 v58, v151, v147, s46
    v_perm_b32 v59, v159, v155, s46
    v_perm_b32 v60, v167, v163, s46
    v_perm_b32 v61, v111, v107, s46
    s_waitcnt lgkmcnt(1)
    v_fmac_f32 v30, v90, v66
    v_fmac_f32 v30, v91, v67
    v_fmac_f32 v30, v92, v68
    v_fmac_f32 v30, v93, v69
    ds_read_b128 v[90:93], v98 offset:6144
    v_mfma_f32_16x16x32_bf16 v[74:77], v[34:37], v[58:61], 0
    v_perm_b32 v62, v151, v147, s47
    v_perm_b32 v63, v159, v155, s47
    v_perm_b32 v64, v167, v163, s47
    v_perm_b32 v65, v111, v107, s47
    s_waitcnt lgkmcnt(1)
    v_fmac_f32 v31, v94, v70
    v_fmac_f32 v31, v95, v71
    v_fmac_f32 v31, v96, v72
    v_fmac_f32 v31, v97, v73
    ds_read_b128 v[94:97], v98 offset:6400
    v_mfma_f32_16x16x32_bf16 v[66:69], v[34:37], v[62:65], 0
    s_waitcnt lgkmcnt(1)
    v_fmac_f32 v32, v90, v74
    v_fmac_f32 v32, v91, v75
    v_fmac_f32 v32, v92, v76
    v_fmac_f32 v32, v93, v77
    s_waitcnt lgkmcnt(0)
    s_nop 1
    v_fmac_f32 v33, v94, v66
    v_fmac_f32 v33, v95, v67
    v_fmac_f32 v33, v96, v68
    v_fmac_f32 v33, v97, v69
K2_SVA4:
    s_cmp_le_u32 s54, 32
    s_cbranch_scc1 K2_KDONE
    s_sub_u32 s54, s54, 32
    v_add_u32 v1, 1024, v1
    ds_read_b128 v[50:53], v102 offset:128
    ds_read_b128 v[54:57], v102 offset:144
    s_branch K2_KSTEP
K2_V3:
    buffer_load_dwordx4 v[104:107], v50, s[28:31], 0 offen offset:1024 sc1
    buffer_load_dwordx4 v[108:111], v51, s[28:31], 0 offen offset:1024 sc1
    buffer_load_dwordx4 v[112:115], v52, s[28:31], 0 offen offset:1024 sc1
    buffer_load_dwordx4 v[116:119], v53, s[28:31], 0 offen offset:1024 sc1
    buffer_load_dwordx4 v[120:123], v54, s[28:31], 0 offen offset:1024 sc1
    buffer_load_dwordx4 v[124:127], v55, s[28:31], 0 offen offset:1024 sc1
    buffer_load_dwordx4 v[128:131], v50, s[28:31], 0 offen offset:0 sc1
    buffer_load_dwordx4 v[132:135], v51, s[28:31], 0 offen offset:0 sc1
    buffer_load_dwordx4 v[136:139], v52, s[28:31], 0 offen offset:0 sc1
    buffer_load_dwordx4 v[140:143], v53, s[28:31], 0 offen offset:0 sc1
    buffer_load_dwordx4 v[144:147], v54, s[28:31], 0 offen offset:0 sc1
    buffer_load_dwordx4 v[148:151], v55, s[28:31], 0 offen offset:0 sc1
    buffer_load_dwordx4 v[152:155], v50, s[28:31], 0 offen offset:256 sc1
    buffer_load_dwordx4 v[156:159], v51, s[28:31], 0 offen offset:256 sc1
    buffer_load_dwordx4 v[160:163], v52, s[28:31], 0 offen offset:256 sc1
    buffer_load_dwordx4 v[164:167], v53, s[28:31], 0 offen offset:256 sc1
    s_cmp_lg_u32 s57, 0
    s_cbranch_scc1 K2_V3_GO
    s_waitcnt vmcnt(16)
    v_lshlrev_b32 v2, 16, v18
    v_and_b32 v3, 0xffff0000, v18
    v_lshlrev_b32 v4, 16, v19
    v_and_b32 v5, 0xffff0000, v19
    v_lshlrev_b32 v6, 16, v20
    v_and_b32 v7, 0xffff0000, v20
    v_lshlrev_b32 v8, 16, v21
    v_and_b32 v9, 0xffff0000, v21
    v_lshlrev_b32 v10, 16, v22
    v_and_b32 v11, 0xffff0000, v22
    v_lshlrev_b32 v12, 16, v23
    v_and_b32 v13, 0xffff0000, v23
    v_lshlrev_b32 v14, 16, v24
    v_and_b32 v15, 0xffff0000, v24
    v_lshlrev_b32 v16, 16, v25
    v_and_b32 v17, 0xffff0000, v25
    v_lshlrev_b32 v18, 16, v26
    v_and_b32 v19, 0xffff0000, v26
    v_lshlrev_b32 v20, 16, v27
    v_and_b32 v21, 0xffff0000, v27
    v_lshlrev_b32 v22, 16, v28
    v_and_b32 v23, 0xffff0000, v28
    v_lshlrev_b32 v24, 16, v29
    v_and_b32 v25, 0xffff0000, v29
    v_lshlrev_b32 v26, 16, v30
    v_and_b32 v27, 0xffff0000, v30
    v_lshlrev_b32 v28, 16, v31
    v_and_b32 v29, 0xffff0000, v31
    v_lshlrev_b32 v30, 16, v32
    v_and_b32 v31, 0xffff0000, v32
    v_lshlrev_b32 v32, 16, v33
    v_and_b32 v33, 0xffff0000, v33
    s_mov_b32 s57, 1
K2_V3_GO:
    ds_read_b128 v[90:93], v98 offset:6656
    ds_read_b128 v[94:97], v98 offset:6912
    s_waitcnt vmcnt(10)
    v_perm_b32 v58, v108, v104, s46
    v_perm_b32 v59, v116, v112, s46
    v_perm_b32 v60, v124, v120, s46
    s_waitcnt lgkmcnt(2)
    s_nop 0
    v_mfma_f32_16x16x32_bf16 v[66:69], v[38:41], v[58:61], 0
    v_mfma_f32_16x16x32_bf16 v[70:73], v[42:45], v[58:61], 0
    v_mfma_f32_16x16x32_bf16 v[74:77], v[46:49], v[58:61], 0
    v_perm_b32 v62, v108, v104, s47
    v_perm_b32 v63, v116, v112, s47
    v_perm_b32 v64, v124, v120, s47
    s_nop 1
    v_mfma_f32_16x16x32_bf16 v[78:81], v[38:41], v[62:65], 0
    v_mfma_f32_16x16x32_bf16 v[82:85], v[42:45], v[62:65], 0
    v_mfma_f32_16x16x32_bf16 v[86:89], v[46:49], v[62:65], 0
    v_perm_b32 v58, v109, v105, s46
    v_perm_b32 v59, v117, v113, s46
    v_perm_b32 v60, v125, v121, s46
    s_waitcnt lgkmcnt(1)
    v_fmac_f32 v10, v90, v66
    v_fmac_f32 v18, v90, v70
    v_fmac_f32 v26, v90, v74
    v_fmac_f32 v10, v91, v67
    v_fmac_f32 v18, v91, v71
    v_fmac_f32 v26, v91, v75
    v_fmac_f32 v10, v92, v68
    v_fmac_f32 v18, v92, v72
    v_fmac_f32 v26, v92, v76
    v_fmac_f32 v10, v93, v69
    v_fmac_f32 v18, v93, v73
    v_fmac_f32 v26, v93, v77
    ds_read_b128 v[90:93], v98 offset:7168
    v_mfma_f32_16x16x32_bf16 v[66:69], v[38:41], v[58:61], 0
    v_mfma_f32_16x16x32_bf16 v[70:73], v[42:45], v[58:61], 0
    v_mfma_f32_16x16x32_bf16 v[74:77], v[46:49], v[58:61], 0
    v_perm_b32 v62, v109, v105, s47
    v_perm_b32 v63, v117, v113, s47
    v_perm_b32 v64, v125, v121, s47
    s_waitcnt lgkmcnt(1)
    v_fmac_f32 v11, v94, v78
    v_fmac_f32 v19, v94, v82
    v_fmac_f32 v27, v94, v86
    v_fmac_f32 v11, v95, v79
    v_fmac_f32 v19, v95, v83
    v_fmac_f32 v27, v95, v87
    v_fmac_f32 v11, v96, v80
    v_fmac_f32 v19, v96, v84
    v_fmac_f32 v27, v96, v88
    v_fmac_f32 v11, v97, v81
    v_fmac_f32 v19, v97, v85
    v_fmac_f32 v27, v97, v89
    ds_read_b128 v[94:97], v98 offset:7424
    v_mfma_f32_16x16x32_bf16 v[78:81], v[38:41], v[62:65], 0
    v_mfma_f32_16x16x32_bf16 v[82:85], v[42:45], v[62:65], 0
    v_mfma_f32_16x16x32_bf16 v[86:89], v[46:49], v[62:65], 0
    v_perm_b32 v58, v110, v106, s46
    v_perm_b32 v59, v118, v114, s46
    v_perm_b32 v60, v126, v122, s46
    s_waitcnt lgkmcnt(1)
    v_fmac_f32 v12, v90, v66
    v_fmac_f32 v20, v90, v70
    v_fmac_f32 v28, v90, v74
    v_fmac_f32 v12, v91, v67
    v_fmac_f32 v20, v91, v71
    v_fmac_f32 v28, v91, v75
    v_fmac_f32 v12, v92, v68
    v_fmac_f32 v20, v92, v72
    v_fmac_f32 v28, v92, v76
    v_fmac_f32 v12, v93, v69
    v_fmac_f32 v20, v93, v73
    v_fmac_f32 v28, v93, v77
    ds_read_b128 v[90:93], v98 offset:7680
    v_mfma_f32_16x16x32_bf16 v[66:69], v[38:41], v[58:61], 0
    v_mfma_f32_16x16x32_bf16 v[70:73], v[42:45], v[58:61], 0
    v_mfma_f32_16x16x32_bf16 v[74:77], v[46:49], v[58:61], 0
    v_perm_b32 v62, v110, v106, s47
    v_perm_b32 v63, v118, v114, s47
    v_perm_b32 v64, v126, v122, s47
    s_waitcnt lgkmcnt(1)
    v_fmac_f32 v13, v94, v78
    v_fmac_f32 v21, v94, v82
    v_fmac_f32 v29, v94, v86
    v_fmac_f32 v13, v95, v79
    v_fmac_f32 v21, v95, v83
    v_fmac_f32 v29, v95, v87
    v_fmac_f32 v13, v96, v80
    v_fmac_f32 v21, v96, v84
    v_fmac_f32 v29, v96, v88
    v_fmac_f32 v13, v97, v81
    v_fmac_f32 v21, v97, v85
    v_fmac_f32 v29, v97, v89
    ds_read_b128 v[94:97], v98 offset:7936
    v_mfma_f32_16x16x32_bf16 v[78:81], v[38:41], v[62:65], 0
    v_mfma_f32_16x16x32_bf16 v[82:85], v[42:45], v[62:65], 0
    v_mfma_f32_16x16x32_bf16 v[86:89], v[46:49], v[62:65], 0
    v_perm_b32 v58, v111, v107, s46
    v_perm_b32 v59, v119, v115, s46
    v_perm_b32 v60, v127, v123, s46
    s_waitcnt lgkmcnt(1)
    v_fmac_f32 v14, v90, v66
    v_fmac_f32 v22, v90, v70
    v_fmac_f32 v30, v90, v74
    v_fmac_f32 v14, v91, v67
    v_fmac_f32 v22, v91, v71
    v_fmac_f32 v30, v91, v75
    v_fmac_f32 v14, v92, v68
    v_fmac_f32 v22, v92, v72
    v_fmac_f32 v30, v92, v76
    v_fmac_f32 v14, v93, v69
    v_fmac_f32 v22, v93, v73
    v_fmac_f32 v30, v93, v77
    ds_read_b128 v[90:93], v98 offset:8192
    v_mfma_f32_16x16x32_bf16 v[66:69], v[38:41], v[58:61], 0
    v_mfma_f32_16x16x32_bf16 v[70:73], v[42:45], v[58:61], 0
    v_mfma_f32_16x16x32_bf16 v[74:77], v[46:49], v[58:61], 0
    v_perm_b32 v62, v111, v107, s47
    v_perm_b32 v63, v119, v115, s47
    v_perm_b32 v64, v127, v123, s47
    buffer_load_dwordx4 v[104:107], v54, s[28:31], 0 offen offset:256 sc1
    buffer_load_dwordx4 v[108:111], v55, s[28:31], 0 offen offset:256 sc1
    buffer_load_dwordx4 v[112:115], v50, s[28:31], 0 offen offset:512 sc1
    buffer_load_dwordx4 v[116:119], v51, s[28:31], 0 offen offset:512 sc1
    buffer_load_dwordx4 v[120:123], v52, s[28:31], 0 offen offset:512 sc1
    buffer_load_dwordx4 v[124:127], v53, s[28:31], 0 offen offset:512 sc1
    s_waitcnt lgkmcnt(1)
    v_fmac_f32 v15, v94, v78
    v_fmac_f32 v23, v94, v82
    v_fmac_f32 v31, v94, v86
    v_fmac_f32 v15, v95, v79
    v_fmac_f32 v23, v95, v83
    v_fmac_f32 v31, v95, v87
    v_fmac_f32 v15, v96, v80
    v_fmac_f32 v23, v96, v84
    v_fmac_f32 v31, v96, v88
    v_fmac_f32 v15, v97, v81
    v_fmac_f32 v23, v97, v85
    v_fmac_f32 v31, v97, v89
    ds_read_b128 v[94:97], v98 offset:8448
    v_mfma_f32_16x16x32_bf16 v[78:81], v[38:41], v[62:65], 0
    v_mfma_f32_16x16x32_bf16 v[82:85], v[42:45], v[62:65], 0
    v_mfma_f32_16x16x32_bf16 v[86:89], v[46:49], v[62:65], 0
    s_waitcnt vmcnt(10)
    v_perm_b32 v58, v132, v128, s46
    v_perm_b32 v59, v140, v136, s46
    v_perm_b32 v60, v148, v144, s46
    s_waitcnt lgkmcnt(1)
    v_fmac_f32 v16, v90, v66
    v_fmac_f32 v24, v90, v70
    v_fmac_f32 v32, v90, v74
    v_fmac_f32 v16, v91, v67
    v_fmac_f32 v24, v91, v71
    v_fmac_f32 v32, v91, v75
    v_fmac_f32 v16, v92, v68
    v_fmac_f32 v24, v92, v72
    v_fmac_f32 v32, v92, v76
    v_fmac_f32 v16, v93, v69
    v_fmac_f32 v24, v93, v73
    v_fmac_f32 v32, v93, v77
    ds_read_b128 v[90:93], v98 offset:2560
    v_mfma_f32_16x16x32_bf16 v[74:77], v[34:37], v[58:61], 0
    v_perm_b32 v62, v132, v128, s47
    v_perm_b32 v63, v140, v136, s47
    v_perm_b32 v64, v148, v144, s47
    s_waitcnt lgkmcnt(1)
    v_fmac_f32 v17, v94, v78
    v_fmac_f32 v25, v94, v82
    v_fmac_f32 v33, v94, v86
    v_fmac_f32 v17, v95, v79
    v_fmac_f32 v25, v95, v83
    v_fmac_f32 v33, v95, v87
    v_fmac_f32 v17, v96, v80
    v_fmac_f32 v25, v96, v84
    v_fmac_f32 v33, v96, v88
    v_fmac_f32 v17, v97, v81
    v_fmac_f32 v25, v97, v85
    v_fmac_f32 v33, v97, v89
    ds_read_b128 v[94:97], v98 offset:2816
    buffer_load_dwordx4 v[38:41], v54, s[28:31], 0 offen offset:512 sc1
    buffer_load_dwordx4 v[42:45], v55, s[28:31], 0 offen offset:512 sc1
    buffer_load_dwordx4 v[46:49], v50, s[28:31], 0 offen offset:768 sc1
    buffer_load_dwordx4 v[78:81], v51, s[28:31], 0 offen offset:768 sc1
    buffer_load_dwordx4 v[82:85], v52, s[28:31], 0 offen offset:768 sc1
    buffer_load_dwordx4 v[86:89], v53, s[28:31], 0 offen offset:768 sc1
    v_mfma_f32_16x16x32_bf16 v[66:69], v[34:37], v[62:65], 0
    v_perm_b32 v58, v133, v129, s46
    v_perm_b32 v59, v141, v137, s46
    v_perm_b32 v60, v149, v145, s46
    s_waitcnt lgkmcnt(1)
    v_fmac_f32 v2, v90, v74
    v_fmac_f32 v2, v91, v75
    v_fmac_f32 v2, v92, v76
    v_fmac_f32 v2, v93, v77
    ds_read_b128 v[90:93], v98 offset:3072
    v_mfma_f32_16x16x32_bf16 v[70:73], v[34:37], v[58:61], 0
    v_perm_b32 v62, v133, v129, s47
    v_perm_b32 v63, v141, v137, s47
    v_perm_b32 v64, v149, v145, s47
    s_waitcnt lgkmcnt(1)
    v_fmac_f32 v3, v94, v66
    v_fmac_f32 v3, v95, v67
    v_fmac_f32 v3, v96, v68
    v_fmac_f32 v3, v97, v69
    ds_read_b128 v[94:97], v98 offset:3328
    v_mfma_f32_16x16x32_bf16 v[74:77], v[34:37], v[62:65], 0
    v_perm_b32 v58, v134, v130, s46
    v_perm_b32 v59, v142, v138, s46
    v_perm_b32 v60, v150, v146, s46
    s_waitcnt lgkmcnt(1)
    v_fmac_f32 v4, v90, v70
    v_fmac_f32 v4, v91, v71
    v_fmac_f32 v4, v92, v72
    v_fmac_f32 v4, v93, v73
    ds_read_b128 v[90:93], v98 offset:3584
    v_mfma_f32_16x16x32_bf16 v[66:69], v[34:37], v[58:61], 0
    v_perm_b32 v62, v134, v130, s47
    v_perm_b32 v63, v142, v138, s47
    v_perm_b32 v64, v150, v146, s47
    s_waitcnt lgkmcnt(1)
    v_fmac_f32 v5, v94, v74
    v_fmac_f32 v5, v95, v75
    v_fmac_f32 v5, v96, v76
    v_fmac_f32 v5, v97, v77
    ds_read_b128 v[94:97], v98 offset:3840
    v_mfma_f32_16x16x32_bf16 v[70:73], v[34:37], v[62:65], 0
    v_perm_b32 v58, v135, v131, s46
    v_perm_b32 v59, v143, v139, s46
    v_perm_b32 v60, v151, v147, s46
    s_waitcnt lgkmcnt(1)
    v_fmac_f32 v6, v90, v66
    v_fmac_f32 v6, v91, v67
    v_fmac_f32 v6, v92, v68
    v_fmac_f32 v6, v93, v69
    ds_read_b128 v[90:93], v98 offset:4096
    v_mfma_f32_16x16x32_bf16 v[74:77], v[34:37], v[58:61], 0
    v_perm_b32 v62, v135, v131, s47
    v_perm_b32 v63, v143, v139, s47
    v_perm_b32 v64, v151, v147, s47
    buffer_load_dwordx4 v[128:131], v54, s[28:31], 0 offen offset:768 sc1
    buffer_load_dwordx4 v[132:135], v55, s[28:31], 0 offen offset:768 sc1
    s_waitcnt lgkmcnt(1)
    v_fmac_f32 v7, v94, v70
    v_fmac_f32 v7, v95, v71
    v_fmac_f32 v7, v96, v72
    v_fmac_f32 v7, v97, v73
    ds_read_b128 v[94:97], v98 offset:4352
    v_mfma_f32_16x16x32_bf16 v[66:69], v[34:37], v[62:65], 0
    s_waitcnt vmcnt(12)
    v_perm_b32 v58, v156, v152, s46
    v_perm_b32 v59, v164, v160, s46
    v_perm_b32 v60, v108, v104, s46
    s_waitcnt lgkmcnt(1)
    v_fmac_f32 v8, v90, v74
    v_fmac_f32 v8, v91, v75
    v_fmac_f32 v8, v92, v76
    v_fmac_f32 v8, v93, v77
    ds_read_b128 v[90:93], v98 offset:4608
    v_mfma_f32_16x16x32_bf16 v[70:73], v[34:37], v[58:61], 0
    v_perm_b32 v62, v156, v152, s47
    v_perm_b32 v63, v164, v160, s47
    v_perm_b32 v64, v108, v104, s47
    s_waitcnt lgkmcnt(1)
    v_fmac_f32 v9, v94, v66
    v_fmac_f32 v9, v95, v67
    v_fmac_f32 v9, v96, v68
    v_fmac_f32 v9, v97, v69
    ds_read_b128 v[94:97], v98 offset:4864
    v_mfma_f32_16x16x32_bf16 v[74:77], v[34:37], v[62:65], 0
    v_perm_b32 v58, v157, v153, s46
    v_perm_b32 v59, v165, v161, s46
    v_perm_b32 v60, v109, v105, s46
    s_waitcnt lgkmcnt(1)
    v_fmac_f32 v10, v90, v70
    v_fmac_f32 v10, v91, v71
    v_fmac_f32 v10, v92, v72
    v_fmac_f32 v10, v93, v73
    ds_read_b128 v[90:93], v98 offset:5120
    v_mfma_f32_16x16x32_bf16 v[66:69], v[34:37], v[58:61], 0
    v_perm_b32 v62, v157, v153, s47
    v_perm_b32 v63, v165, v161, s47
    v_perm_b32 v64, v109, v105, s47
    s_waitcnt lgkmcnt(1)
    v_fmac_f32 v11, v94, v74
    v_fmac_f32 v11, v95, v75
    v_fmac_f32 v11, v96, v76
    v_fmac_f32 v11, v97, v77
    ds_read_b128 v[94:97], v98 offset:5376
    v_mfma_f32_16x16x32_bf16 v[70:73], v[34:37], v[62:65], 0
    v_perm_b32 v58, v158, v154, s46
    v_perm_b32 v59, v166, v162, s46
    v_perm_b32 v60, v110, v106, s46
    s_waitcnt lgkmcnt(1)
    v_fmac_f32 v12, v90, v66
    v_fmac_f32 v12, v91, v67
    v_fmac_f32 v12, v92, v68
    v_fmac_f32 v12, v93, v69
    ds_read_b128 v[90:93], v98 offset:5632
    v_mfma_f32_16x16x32_bf16 v[74:77], v[34:37], v[58:61], 0
    v_perm_b32 v62, v158, v154, s47
    v_perm_b32 v63, v166, v162, s47
    v_perm_b32 v64, v110, v106, s47
    s_waitcnt lgkmcnt(1)
    v_fmac_f32 v13, v94, v70
    v_fmac_f32 v13, v95, v71
    v_fmac_f32 v13, v96, v72
    v_fmac_f32 v13, v97, v73
    ds_read_b128 v[94:97], v98 offset:5888
    v_mfma_f32_16x16x32_bf16 v[66:69], v[34:37], v[62:65], 0
    v_perm_b32 v58, v159, v155, s46
    v_perm_b32 v59, v167, v163, s46
    v_perm_b32 v60, v111, v107, s46
    s_waitcnt lgkmcnt(1)
    v_fmac_f32 v14, v90, v74
    v_fmac_f32 v14, v91, v75
    v_fmac_f32 v14, v92, v76
    v_fmac_f32 v14, v93, v77
    ds_read_b128 v[90:93], v98 offset:6144
    v_mfma_f32_16x16x32_bf16 v[70:73], v[34:37], v[58:61], 0
    v_perm_b32 v62, v159, v155, s47
    v_perm_b32 v63, v167, v163, s47
    v_perm_b32 v64, v111, v107, s47
    s_waitcnt lgkmcnt(1)
    v_fmac_f32 v15, v94, v66
    v_fmac_f32 v15, v95, v67
    v_fmac_f32 v15, v96, v68
    v_fmac_f32 v15, v97, v69
    ds_read_b128 v[94:97], v98 offset:6400
    v_mfma_f32_16x16x32_bf16 v[74:77], v[34:37], v[62:65], 0
    s_waitcnt vmcnt(6)
    v_perm_b32 v58, v116, v112, s46
    v_perm_b32 v59, v124, v120, s46
    v_perm_b32 v60, v42, v38, s46
    s_waitcnt lgkmcnt(1)
    v_fmac_f32 v16, v90, v70
    v_fmac_f32 v16, v91, v71
    v_fmac_f32 v16, v92, v72
    v_fmac_f32 v16, v93, v73
    ds_read_b128 v[90:93], v98 offset:4608
    v_mfma_f32_16x16x32_bf16 v[66:69], v[34:37], v[58:61], 0
    v_perm_b32 v62, v116, v112, s47
    v_perm_b32 v63, v124, v120, s47
    v_perm_b32 v64, v42, v38, s47
    s_waitcnt lgkmcnt(1)
    v_fmac_f32 v17, v94, v74
    v_fmac_f32 v17, v95, v75
    v_fmac_f32 v17, v96, v76
    v_fmac_f32 v17, v97, v77
    ds_read_b128 v[94:97], v98 offset:4864
    v_mfma_f32_16x16x32_bf16 v[70:73], v[34:37], v[62:65], 0
    v_perm_b32 v58, v117, v113, s46
    v_perm_b32 v59, v125, v121, s46
    v_perm_b32 v60, v43, v39, s46
    s_waitcnt lgkmcnt(1)
    v_fmac_f32 v18, v90, v66
    v_fmac_f32 v18, v91, v67
    v_fmac_f32 v18, v92, v68
    v_fmac_f32 v18, v93, v69
    ds_read_b128 v[90:93], v98 offset:5120
    v_mfma_f32_16x16x32_bf16 v[74:77], v[34:37], v[58:61], 0
    v_perm_b32 v62, v117, v113, s47
    v_perm_b32 v63, v125, v121, s47
    v_perm_b32 v64, v43, v39, s47
    s_waitcnt lgkmcnt(1)
    v_fmac_f32 v19, v94, v70
    v_fmac_f32 v19, v95, v71
    v_fmac_f32 v19, v96, v72
    v_fmac_f32 v19, v97, v73
    ds_read_b128 v[94:97], v98 offset:5376
    v_mfma_f32_16x16x32_bf16 v[66:69], v[34:37], v[62:65], 0
    v_perm_b32 v58, v118, v114, s46
    v_perm_b32 v59, v126, v122, s46
    v_perm_b32 v60, v44, v40, s46
    s_waitcnt lgkmcnt(1)
    v_fmac_f32 v20, v90, v74
    v_fmac_f32 v20, v91, v75
    v_fmac_f32 v20, v92, v76
    v_fmac_f32 v20, v93, v77
    ds_read_b128 v[90:93], v98 offset:5632
    v_mfma_f32_16x16x32_bf16 v[70:73], v[34:37], v[58:61], 0
    v_perm_b32 v62, v118, v114, s47
    v_perm_b32 v63, v126, v122, s47
    v_perm_b32 v64, v44, v40, s47
    s_waitcnt lgkmcnt(1)
    v_fmac_f32 v21, v94, v66
    v_fmac_f32 v21, v95, v67
    v_fmac_f32 v21, v96, v68
    v_fmac_f32 v21, v97, v69
    ds_read_b128 v[94:97], v98 offset:5888
    v_mfma_f32_16x16x32_bf16 v[74:77], v[34:37], v[62:65], 0
    v_perm_b32 v58, v119, v115, s46
    v_perm_b32 v59, v127, v123, s46
    v_perm_b32 v60, v45, v41, s46
    s_waitcnt lgkmcnt(1)
    v_fmac_f32 v22, v90, v70
    v_fmac_f32 v22, v91, v71
    v_fmac_f32 v22, v92, v72
    v_fmac_f32 v22, v93, v73
    ds_read_b128 v[90:93], v98 offset:6144
    v_mfma_f32_16x16x32_bf16 v[66:69], v[34:37], v[58:61], 0
    v_perm_b32 v62, v119, v115, s47
    v_perm_b32 v63, v127, v123, s47
    v_perm_b32 v64, v45, v41, s47
    s_waitcnt lgkmcnt(1)
    v_fmac_f32 v23, v94, v74
    v_fmac_f32 v23, v95, v75
    v_fmac_f32 v23, v96, v76
    v_fmac_f32 v23, v97, v77
    ds_read_b128 v[94:97], v98 offset:6400
    v_mfma_f32_16x16x32_bf16 v[70:73], v[34:37], v[62:65], 0
    s_waitcnt vmcnt(0)
    v_perm_b32 v58, v78, v46, s46
    v_perm_b32 v59, v86, v82, s46
    v_perm_b32 v60, v132, v128, s46
    s_waitcnt lgkmcnt(1)
    v_fmac_f32 v24, v90, v66
    v_fmac_f32 v24, v91, v67
    v_fmac_f32 v24, v92, v68
    v_fmac_f32 v24, v93, v69
    ds_read_b128 v[90:93], v98 offset:4608
    v_mfma_f32_16x16x32_bf16 v[74:77], v[34:37], v[58:61], 0
    v_perm_b32 v62, v78, v46, s47
    v_perm_b32 v63, v86, v82, s47
    v_perm_b32 v64, v132, v128, s47
    s_waitcnt lgkmcnt(1)
    v_fmac_f32 v25, v94, v70
    v_fmac_f32 v25, v95, v71
    v_fmac_f32 v25, v96, v72
    v_fmac_f32 v25, v97, v73
    ds_read_b128 v[94:97], v98 offset:4864
    v_mfma_f32_16x16x32_bf16 v[66:69], v[34:37], v[62:65], 0
    v_perm_b32 v58, v79, v47, s46
    v_perm_b32 v59, v87, v83, s46
    v_perm_b32 v60, v133, v129, s46
    s_waitcnt lgkmcnt(1)
    v_fmac_f32 v26, v90, v74
    v_fmac_f32 v26, v91, v75
    v_fmac_f32 v26, v92, v76
    v_fmac_f32 v26, v93, v77
    ds_read_b128 v[90:93], v98 offset:5120
    v_mfma_f32_16x16x32_bf16 v[70:73], v[34:37], v[58:61], 0
    v_perm_b32 v62, v79, v47, s47
    v_perm_b32 v63, v87, v83, s47
    v_perm_b32 v64, v133, v129, s47
    s_waitcnt lgkmcnt(1)
    v_fmac_f32 v27, v94, v66
    v_fmac_f32 v27, v95, v67
    v_fmac_f32 v27, v96, v68
    v_fmac_f32 v27, v97, v69
    ds_read_b128 v[94:97], v98 offset:5376
    v_mfma_f32_16x16x32_bf16 v[74:77], v[34:37], v[62:65], 0
    v_perm_b32 v58, v80, v48, s46
    v_perm_b32 v59, v88, v84, s46
    v_perm_b32 v60, v134, v130, s46
    s_waitcnt lgkmcnt(1)
    v_fmac_f32 v28, v90, v70
    v_fmac_f32 v28, v91, v71
    v_fmac_f32 v28, v92, v72
    v_fmac_f32 v28, v93, v73
    ds_read_b128 v[90:93], v98 offset:5632
    v_mfma_f32_16x16x32_bf16 v[66:69], v[34:37], v[58:61], 0
    v_perm_b32 v62, v80, v48, s47
    v_perm_b32 v63, v88, v84, s47
    v_perm_b32 v64, v134, v130, s47
    s_waitcnt lgkmcnt(1)
    v_fmac_f32 v29, v94, v74
    v_fmac_f32 v29, v95, v75
    v_fmac_f32 v29, v96, v76
    v_fmac_f32 v29, v97, v77
    ds_read_b128 v[94:97], v98 offset:5888
    v_mfma_f32_16x16x32_bf16 v[70:73], v[34:37], v[62:65], 0
    v_perm_b32 v58, v81, v49, s46
    v_perm_b32 v59, v89, v85, s46
    v_perm_b32 v60, v135, v131, s46
    s_waitcnt lgkmcnt(1)
    v_fmac_f32 v30, v90, v66
    v_fmac_f32 v30, v91, v67
    v_fmac_f32 v30, v92, v68
    v_fmac_f32 v30, v93, v69
    ds_read_b128 v[90:93], v98 offset:6144
    v_mfma_f32_16x16x32_bf16 v[74:77], v[34:37], v[58:61], 0
    v_perm_b32 v62, v81, v49, s47
    v_perm_b32 v63, v89, v85, s47
    v_perm_b32 v64, v135, v131, s47
    s_waitcnt lgkmcnt(1)
    v_fmac_f32 v31, v94, v70
    v_fmac_f32 v31, v95, v71
    v_fmac_f32 v31, v96, v72
    v_fmac_f32 v31, v97, v73
    ds_read_b128 v[94:97], v98 offset:6400
    v_mfma_f32_16x16x32_bf16 v[66:69], v[34:37], v[62:65], 0
    s_waitcnt lgkmcnt(1)
    v_fmac_f32 v32, v90, v74
    v_fmac_f32 v32, v91, v75
    v_fmac_f32 v32, v92, v76
    v_fmac_f32 v32, v93, v77
    s_waitcnt lgkmcnt(0)
    s_nop 1
    v_fmac_f32 v33, v94, v66
    v_fmac_f32 v33, v95, v67
    v_fmac_f32 v33, v96, v68
    v_fmac_f32 v33, v97, v69
    s_branch K2_SVADD
K2_V2:
    buffer_load_dwordx4 v[104:107], v50, s[28:31], 0 offen offset:1024 sc1
    buffer_load_dwordx4 v[108:111], v51, s[28:31], 0 offen offset:1024 sc1
    buffer_load_dwordx4 v[112:115], v52, s[28:31], 0 offen offset:1024 sc1
    buffer_load_dwordx4 v[116:119], v53, s[28:31], 0 offen offset:1024 sc1
    buffer_load_dwordx4 v[120:123], v50, s[28:31], 0 offen offset:0 sc1
    buffer_load_dwordx4 v[124:127], v51, s[28:31], 0 offen offset:0 sc1
    buffer_load_dwordx4 v[128:131], v52, s[28:31], 0 offen offset:0 sc1
    buffer_load_dwordx4 v[132:135], v53, s[28:31], 0 offen offset:0 sc1
    buffer_load_dwordx4 v[136:139], v50, s[28:31], 0 offen offset:256 sc1
    buffer_load_dwordx4 v[140:143], v51, s[28:31], 0 offen offset:256 sc1
    buffer_load_dwordx4 v[144:147], v52, s[28:31], 0 offen offset:256 sc1
    buffer_load_dwordx4 v[148:151], v53, s[28:31], 0 offen offset:256 sc1
    buffer_load_dwordx4 v[152:155], v50, s[28:31], 0 offen offset:512 sc1
    buffer_load_dwordx4 v[156:159], v51, s[28:31], 0 offen offset:512 sc1
    buffer_load_dwordx4 v[160:163], v52, s[28:31], 0 offen offset:512 sc1
    buffer_load_dwordx4 v[164:167], v53, s[28:31], 0 offen offset:512 sc1
    s_cmp_lg_u32 s57, 0
    s_cbranch_scc1 K2_V2_GO
    s_waitcnt vmcnt(16)
    v_lshlrev_b32 v2, 16, v18
    v_and_b32 v3, 0xffff0000, v18
    v_lshlrev_b32 v4, 16, v19
    v_and_b32 v5, 0xffff0000, v19
    v_lshlrev_b32 v6, 16, v20
    v_and_b32 v7, 0xffff0000, v20
    v_lshlrev_b32 v8, 16, v21
    v_and_b32 v9, 0xffff0000, v21
    v_lshlrev_b32 v10, 16, v22
    v_and_b32 v11, 0xffff0000, v22
    v_lshlrev_b32 v12, 16, v23
    v_and_b32 v13, 0xffff0000, v23
    v_lshlrev_b32 v14, 16, v24
    v_and_b32 v15, 0xffff0000, v24
    v_lshlrev_b32 v16, 16, v25
    v_and_b32 v17, 0xffff0000, v25
    v_lshlrev_b32 v18, 16, v26
    v_and_b32 v19, 0xffff0000, v26
    v_lshlrev_b32 v20, 16, v27
    v_and_b32 v21, 0xffff0000, v27
    v_lshlrev_b32 v22, 16, v28
    v_and_b32 v23, 0xffff0000, v28
    v_lshlrev_b32 v24, 16, v29
    v_and_b32 v25, 0xffff0000, v29
    v_lshlrev_b32 v26, 16, v30
    v_and_b32 v27, 0xffff0000, v30
    v_lshlrev_b32 v28, 16, v31
    v_and_b32 v29, 0xffff0000, v31
    v_lshlrev_b32 v30, 16, v32
    v_and_b32 v31, 0xffff0000, v32
    v_lshlrev_b32 v32, 16, v33
    v_and_b32 v33, 0xffff0000, v33
    s_mov_b32 s57, 1
K2_V2_GO:
    ds_read_b128 v[90:93], v98 offset:6656
    ds_read_b128 v[94:97], v98 offset:6912
    s_waitcnt vmcnt(12)
    v_perm_b32 v58, v108, v104, s46
    v_perm_b32 v59, v116, v112, s46
    s_waitcnt lgkmcnt(2)
    s_nop 0
    v_mfma_f32_16x16x32_bf16 v[66:69], v[38:41], v[58:61], 0
    v_mfma_f32_16x16x32_bf16 v[70:73], v[42:45], v[58:61], 0
    v_mfma_f32_16x16x32_bf16 v[74:77], v[46:49], v[58:61], 0
    v_perm_b32 v62, v108, v104, s47
    v_perm_b32 v63, v116, v112, s47
    s_nop 1
    v_mfma_f32_16x16x32_bf16 v[78:81], v[38:41], v[62:65], 0
    v_mfma_f32_16x16x32_bf16 v[82:85], v[42:45], v[62:65], 0
    v_mfma_f32_16x16x32_bf16 v[86:89], v[46:49], v[62:65], 0
    v_perm_b32 v58, v109, v105, s46
    v_perm_b32 v59, v117, v113, s46
    s_waitcnt lgkmcnt(1)
    v_fmac_f32 v10, v90, v66
    v_fmac_f32 v18, v90, v70
    v_fmac_f32 v26, v90, v74
    v_fmac_f32 v10, v91, v67
    v_fmac_f32 v18, v91, v71
    v_fmac_f32 v26, v91, v75
    v_fmac_f32 v10, v92, v68
    v_fmac_f32 v18, v92, v72
    v_fmac_f32 v26, v92, v76
    v_fmac_f32 v10, v93, v69
    v_fmac_f32 v18, v93, v73
    v_fmac_f32 v26, v93, v77
    ds_read_b128 v[90:93], v98 offset:7168
    v_mfma_f32_16x16x32_bf16 v[66:69], v[38:41], v[58:61], 0
    v_mfma_f32_16x16x32_bf16 v[70:73], v[42:45], v[58:61], 0
    v_mfma_f32_16x16x32_bf16 v[74:77], v[46:49], v[58:61], 0
    v_perm_b32 v62, v109, v105, s47
    v_perm_b32 v63, v117, v113, s47
    s_waitcnt lgkmcnt(1)
    v_fmac_f32 v11, v94, v78
    v_fmac_f32 v19, v94, v82
    v_fmac_f32 v27, v94, v86
    v_fmac_f32 v11, v95, v79
    v_fmac_f32 v19, v95, v83
    v_fmac_f32 v27, v95, v87
    v_fmac_f32 v11, v96, v80
    v_fmac_f32 v19, v96, v84
    v_fmac_f32 v27, v96, v88
    v_fmac_f32 v11, v97, v81
    v_fmac_f32 v19, v97, v85
    v_fmac_f32 v27, v97, v89
    ds_read_b128 v[94:97], v98 offset:7424
    v_mfma_f32_16x16x32_bf16 v[78:81], v[38:41], v[62:65], 0
    v_mfma_f32_16x16x32_bf16 v[82:85], v[42:45], v[62:65], 0
    v_mfma_f32_16x16x32_bf16 v[86:89], v[46:49], v[62:65], 0
    v_perm_b32 v58, v110, v106, s46
    v_perm_b32 v59, v118, v114, s46
    s_waitcnt lgkmcnt(1)
    v_fmac_f32 v12, v90, v66
    v_fmac_f32 v20, v90, v70
    v_fmac_f32 v28, v90, v74
    v_fmac_f32 v12, v91, v67
    v_fmac_f32 v20, v91, v71
    v_fmac_f32 v28, v91, v75
    v_fmac_f32 v12, v92, v68
    v_fmac_f32 v20, v92, v72
    v_fmac_f32 v28, v92, v76
    v_fmac_f32 v12, v93, v69
    v_fmac_f32 v20, v93, v73
    v_fmac_f32 v28, v93, v77
    ds_read_b128 v[90:93], v98 offset:7680
    v_mfma_f32_16x16x32_bf16 v[66:69], v[38:41], v[58:61], 0
    v_mfma_f32_16x16x32_bf16 v[70:73], v[42:45], v[58:61], 0
    v_mfma_f32_16x16x32_bf16 v[74:77], v[46:49], v[58:61], 0
    v_perm_b32 v62, v110, v106, s47
    v_perm_b32 v63, v118, v114, s47
    s_waitcnt lgkmcnt(1)
    v_fmac_f32 v13, v94, v78
    v_fmac_f32 v21, v94, v82
    v_fmac_f32 v29, v94, v86
    v_fmac_f32 v13, v95, v79
    v_fmac_f32 v21, v95, v83
    v_fmac_f32 v29, v95, v87
    v_fmac_f32 v13, v96, v80
    v_fmac_f32 v21, v96, v84
    v_fmac_f32 v29, v96, v88
    v_fmac_f32 v13, v97, v81
    v_fmac_f32 v21, v97, v85
    v_fmac_f32 v29, v97, v89
    ds_read_b128 v[94:97], v98 offset:7936
    v_mfma_f32_16x16x32_bf16 v[78:81], v[38:41], v[62:65], 0
    v_mfma_f32_16x16x32_bf16 v[82:85], v[42:45], v[62:65], 0
    v_mfma_f32_16x16x32_bf16 v[86:89], v[46:49], v[62:65], 0
    v_perm_b32 v58, v111, v107, s46
    v_perm_b32 v59, v119, v115, s46
    s_waitcnt lgkmcnt(1)
    v_fmac_f32 v14, v90, v66
    v_fmac_f32 v22, v90, v70
    v_fmac_f32 v30, v90, v74
    v_fmac_f32 v14, v91, v67
    v_fmac_f32 v22, v91, v71
    v_fmac_f32 v30, v91, v75
    v_fmac_f32 v14, v92, v68
    v_fmac_f32 v22, v92, v72
    v_fmac_f32 v30, v92, v76
    v_fmac_f32 v14, v93, v69
    v_fmac_f32 v22, v93, v73
    v_fmac_f32 v30, v93, v77
    ds_read_b128 v[90:93], v98 offset:8192
    v_mfma_f32_16x16x32_bf16 v[66:69], v[38:41], v[58:61], 0
    v_mfma_f32_16x16x32_bf16 v[70:73], v[42:45], v[58:61], 0
    v_mfma_f32_16x16x32_bf16 v[74:77], v[46:49], v[58:61], 0
    v_perm_b32 v62, v111, v107, s47
    v_perm_b32 v63, v119, v115, s47
    buffer_load_dwordx4 v[104:107], v50, s[28:31], 0 offen offset:768 sc1
    buffer_load_dwordx4 v[108:111], v51, s[28:31], 0 offen offset:768 sc1
    buffer_load_dwordx4 v[112:115], v52, s[28:31], 0 offen offset:768 sc1
    buffer_load_dwordx4 v[116:119], v53, s[28:31], 0 offen offset:768 sc1
    s_waitcnt lgkmcnt(1)
    v_fmac_f32 v15, v94, v78
    v_fmac_f32 v23, v94, v82
    v_fmac_f32 v31, v94, v86
    v_fmac_f32 v15, v95, v79
    v_fmac_f32 v23, v95, v83
    v_fmac_f32 v31, v95, v87
    v_fmac_f32 v15, v96, v80
    v_fmac_f32 v23, v96, v84
    v_fmac_f32 v31, v96, v88
    v_fmac_f32 v15, v97, v81
    v_fmac_f32 v23, v97, v85
    v_fmac_f32 v31, v97, v89
    ds_read_b128 v[94:97], v98 offset:8448
    v_mfma_f32_16x16x32_bf16 v[78:81], v[38:41], v[62:65], 0
    v_mfma_f32_16x16x32_bf16 v[82:85], v[42:45], v[62:65], 0
    v_mfma_f32_16x16x32_bf16 v[86:89], v[46:49], v[62:65], 0
    s_waitcnt vmcnt(12)
    v_perm_b32 v58, v124, v120, s46
    v_perm_b32 v59, v132, v128, s46
    s_waitcnt lgkmcnt(1)
    v_fmac_f32 v16, v90, v66
    v_fmac_f32 v24, v90, v70
    v_fmac_f32 v32, v90, v74
    v_fmac_f32 v16, v91, v67
    v_fmac_f32 v24, v91, v71
    v_fmac_f32 v32, v91, v75
    v_fmac_f32 v16, v92, v68
    v_fmac_f32 v24, v92, v72
    v_fmac_f32 v32, v92, v76
    v_fmac_f32 v16, v93, v69
    v_fmac_f32 v24, v93, v73
    v_fmac_f32 v32, v93, v77
    ds_read_b128 v[90:93], v98 offset:2560
    v_mfma_f32_16x16x32_bf16 v[74:77], v[34:37], v[58:61], 0
    v_perm_b32 v62, v124, v120, s47
    v_perm_b32 v63, v132, v128, s47
    s_waitcnt lgkmcnt(1)
    v_fmac_f32 v17, v94, v78
    v_fmac_f32 v25, v94, v82
    v_fmac_f32 v33, v94, v86
    v_fmac_f32 v17, v95, v79
    v_fmac_f32 v25, v95, v83
    v_fmac_f32 v33, v95, v87
    v_fmac_f32 v17, v96, v80
    v_fmac_f32 v25, v96, v84
    v_fmac_f32 v33, v96, v88
    v_fmac_f32 v17, v97, v81
    v_fmac_f32 v25, v97, v85
    v_fmac_f32 v33, v97, v89
    ds_read_b128 v[94:97], v98 offset:2816
    v_mfma_f32_16x16x32_bf16 v[66:69], v[34:37], v[62:65], 0
    v_perm_b32 v58, v125, v121, s46
    v_perm_b32 v59, v133, v129, s46
    s_waitcnt lgkmcnt(1)
    v_fmac_f32 v2, v90, v74
    v_fmac_f32 v2, v91, v75
    v_fmac_f32 v2, v92, v76
    v_fmac_f32 v2, v93, v77
    ds_read_b128 v[90:93], v98 offset:3072
    v_mfma_f32_16x16x32_bf16 v[70:73], v[34:37], v[58:61], 0
    v_perm_b32 v62, v125, v121, s47
    v_perm_b32 v63, v133, v129, s47
    s_waitcnt lgkmcnt(1)
    v_fmac_f32 v3, v94, v66
    v_fmac_f32 v3, v95, v67
    v_fmac_f32 v3, v96, v68
    v_fmac_f32 v3, v97, v69
    ds_read_b128 v[94:97], v98 offset:3328
    v_mfma_f32_16x16x32_bf16 v[74:77], v[34:37], v[62:65], 0
    v_perm_b32 v58, v126, v122, s46
    v_perm_b32 v59, v134, v130, s46
    s_waitcnt lgkmcnt(1)
    v_fmac_f32 v4, v90, v70
    v_fmac_f32 v4, v91, v71
    v_fmac_f32 v4, v92, v72
    v_fmac_f32 v4, v93, v73
    ds_read_b128 v[90:93], v98 offset:3584
    v_mfma_f32_16x16x32_bf16 v[66:69], v[34:37], v[58:61], 0
    v_perm_b32 v62, v126, v122, s47
    v_perm_b32 v63, v134, v130, s47
    s_waitcnt lgkmcnt(1)
    v_fmac_f32 v5, v94, v74
    v_fmac_f32 v5, v95, v75
    v_fmac_f32 v5, v96, v76
    v_fmac_f32 v5, v97, v77
    ds_read_b128 v[94:97], v98 offset:3840
    v_mfma_f32_16x16x32_bf16 v[70:73], v[34:37], v[62:65], 0
    v_perm_b32 v58, v127, v123, s46
    v_perm_b32 v59, v135, v131, s46
    s_waitcnt lgkmcnt(1)
    v_fmac_f32 v6, v90, v66
    v_fmac_f32 v6, v91, v67
    v_fmac_f32 v6, v92, v68
    v_fmac_f32 v6, v93, v69
    ds_read_b128 v[90:93], v98 offset:4096
    v_mfma_f32_16x16x32_bf16 v[74:77], v[34:37], v[58:61], 0
    v_perm_b32 v62, v127, v123, s47
    v_perm_b32 v63, v135, v131, s47
    s_waitcnt lgkmcnt(1)
    v_fmac_f32 v7, v94, v70
    v_fmac_f32 v7, v95, v71
    v_fmac_f32 v7, v96, v72
    v_fmac_f32 v7, v97, v73
    ds_read_b128 v[94:97], v98 offset:4352
    v_mfma_f32_16x16x32_bf16 v[66:69], v[34:37], v[62:65], 0
    s_waitcnt vmcnt(8)
    v_perm_b32 v58, v140, v136, s46
    v_perm_b32 v59, v148, v144, s46
    s_waitcnt lgkmcnt(1)
    v_fmac_f32 v8, v90, v74
    v_fmac_f32 v8, v91, v75
    v_fmac_f32 v8, v92, v76
    v_fmac_f32 v8, v93, v77
    ds_read_b128 v[90:93], v98 offset:4608
    v_mfma_f32_16x16x32_bf16 v[70:73], v[34:37], v[58:61], 0
    v_perm_b32 v62, v140, v136, s47
    v_perm_b32 v63, v148, v144, s47
    s_waitcnt lgkmcnt(1)
    v_fmac_f32 v9, v94, v66
    v_fmac_f32 v9, v95, v67
    v_fmac_f32 v9, v96, v68
    v_fmac_f32 v9, v97, v69
    ds_read_b128 v[94:97], v98 offset:4864
    v_mfma_f32_16x16x32_bf16 v[74:77], v[34:37], v[62:65], 0
    v_perm_b32 v58, v141, v137, s46
    v_perm_b32 v59, v149, v145, s46
    s_waitcnt lgkmcnt(1)
    v_fmac_f32 v10, v90, v70
    v_fmac_f32 v10, v91, v71
    v_fmac_f32 v10, v92, v72
    v_fmac_f32 v10, v93, v73
    ds_read_b128 v[90:93], v98 offset:5120
    v_mfma_f32_16x16x32_bf16 v[66:69], v[34:37], v[58:61], 0
    v_perm_b32 v62, v141, v137, s47
    v_perm_b32 v63, v149, v145, s47
    s_waitcnt lgkmcnt(1)
    v_fmac_f32 v11, v94, v74
    v_fmac_f32 v11, v95, v75
    v_fmac_f32 v11, v96, v76
    v_fmac_f32 v11, v97, v77
    ds_read_b128 v[94:97], v98 offset:5376
    v_mfma_f32_16x16x32_bf16 v[70:73], v[34:37], v[62:65], 0
    v_perm_b32 v58, v142, v138, s46
    v_perm_b32 v59, v150, v146, s46
    s_waitcnt lgkmcnt(1)
    v_fmac_f32 v12, v90, v66
    v_fmac_f32 v12, v91, v67
    v_fmac_f32 v12, v92, v68
    v_fmac_f32 v12, v93, v69
    ds_read_b128 v[90:93], v98 offset:5632
    v_mfma_f32_16x16x32_bf16 v[74:77], v[34:37], v[58:61], 0
    v_perm_b32 v62, v142, v138, s47
    v_perm_b32 v63, v150, v146, s47
    s_waitcnt lgkmcnt(1)
    v_fmac_f32 v13, v94, v70
    v_fmac_f32 v13, v95, v71
    v_fmac_f32 v13, v96, v72
    v_fmac_f32 v13, v97, v73
    ds_read_b128 v[94:97], v98 offset:5888
    v_mfma_f32_16x16x32_bf16 v[66:69], v[34:37], v[62:65], 0
    v_perm_b32 v58, v143, v139, s46
    v_perm_b32 v59, v151, v147, s46
    s_waitcnt lgkmcnt(1)
    v_fmac_f32 v14, v90, v74
    v_fmac_f32 v14, v91, v75
    v_fmac_f32 v14, v92, v76
    v_fmac_f32 v14, v93, v77
    ds_read_b128 v[90:93], v98 offset:6144
    v_mfma_f32_16x16x32_bf16 v[70:73], v[34:37], v[58:61], 0
    v_perm_b32 v62, v143, v139, s47
    v_perm_b32 v63, v151, v147, s47
    s_waitcnt lgkmcnt(1)
    v_fmac_f32 v15, v94, v66
    v_fmac_f32 v15, v95, v67
    v_fmac_f32 v15, v96, v68
    v_fmac_f32 v15, v97, v69
    ds_read_b128 v[94:97], v98 offset:6400
    v_mfma_f32_16x16x32_bf16 v[74:77], v[34:37], v[62:65], 0
    s_waitcnt vmcnt(4)
    v_perm_b32 v58, v156, v152, s46
    v_perm_b32 v59, v164, v160, s46
    s_waitcnt lgkmcnt(1)
    v_fmac_f32 v16, v90, v70
    v_fmac_f32 v16, v91, v71
    v_fmac_f32 v16, v92, v72
    v_fmac_f32 v16, v93, v73
    ds_read_b128 v[90:93], v98 offset:4608
    v_mfma_f32_16x16x32_bf16 v[66:69], v[34:37], v[58:61], 0
    v_perm_b32 v62, v156, v152, s47
    v_perm_b32 v63, v164, v160, s47
    s_waitcnt lgkmcnt(1)
    v_fmac_f32 v17, v94, v74
    v_fmac_f32 v17, v95, v75
    v_fmac_f32 v17, v96, v76
    v_fmac_f32 v17, v97, v77
    ds_read_b128 v[94:97], v98 offset:4864
    v_mfma_f32_16x16x32_bf16 v[70:73], v[34:37], v[62:65], 0
    v_perm_b32 v58, v157, v153, s46
    v_perm_b32 v59, v165, v161, s46
    s_waitcnt lgkmcnt(1)
    v_fmac_f32 v18, v90, v66
    v_fmac_f32 v18, v91, v67
    v_fmac_f32 v18, v92, v68
    v_fmac_f32 v18, v93, v69
    ds_read_b128 v[90:93], v98 offset:5120
    v_mfma_f32_16x16x32_bf16 v[74:77], v[34:37], v[58:61], 0
    v_perm_b32 v62, v157, v153, s47
    v_perm_b32 v63, v165, v161, s47
    s_waitcnt lgkmcnt(1)
    v_fmac_f32 v19, v94, v70
    v_fmac_f32 v19, v95, v71
    v_fmac_f32 v19, v96, v72
    v_fmac_f32 v19, v97, v73
    ds_read_b128 v[94:97], v98 offset:5376
    v_mfma_f32_16x16x32_bf16 v[66:69], v[34:37], v[62:65], 0
    v_perm_b32 v58, v158, v154, s46
    v_perm_b32 v59, v166, v162, s46
    s_waitcnt lgkmcnt(1)
    v_fmac_f32 v20, v90, v74
    v_fmac_f32 v20, v91, v75
    v_fmac_f32 v20, v92, v76
    v_fmac_f32 v20, v93, v77
    ds_read_b128 v[90:93], v98 offset:5632
    v_mfma_f32_16x16x32_bf16 v[70:73], v[34:37], v[58:61], 0
    v_perm_b32 v62, v158, v154, s47
    v_perm_b32 v63, v166, v162, s47
    s_waitcnt lgkmcnt(1)
    v_fmac_f32 v21, v94, v66
    v_fmac_f32 v21, v95, v67
    v_fmac_f32 v21, v96, v68
    v_fmac_f32 v21, v97, v69
    ds_read_b128 v[94:97], v98 offset:5888
    v_mfma_f32_16x16x32_bf16 v[74:77], v[34:37], v[62:65], 0
    v_perm_b32 v58, v159, v155, s46
    v_perm_b32 v59, v167, v163, s46
    s_waitcnt lgkmcnt(1)
    v_fmac_f32 v22, v90, v70
    v_fmac_f32 v22, v91, v71
    v_fmac_f32 v22, v92, v72
    v_fmac_f32 v22, v93, v73
    ds_read_b128 v[90:93], v98 offset:6144
    v_mfma_f32_16x16x32_bf16 v[66:69], v[34:37], v[58:61], 0
    v_perm_b32 v62, v159, v155, s47
    v_perm_b32 v63, v167, v163, s47
    s_waitcnt lgkmcnt(1)
    v_fmac_f32 v23, v94, v74
    v_fmac_f32 v23, v95, v75
    v_fmac_f32 v23, v96, v76
    v_fmac_f32 v23, v97, v77
    ds_read_b128 v[94:97], v98 offset:6400
    v_mfma_f32_16x16x32_bf16 v[70:73], v[34:37], v[62:65], 0
    s_waitcnt vmcnt(0)
    v_perm_b32 v58, v108, v104, s46
    v_perm_b32 v59, v116, v112, s46
    s_waitcnt lgkmcnt(1)
    v_fmac_f32 v24, v90, v66
    v_fmac_f32 v24, v91, v67
    v_fmac_f32 v24, v92, v68
    v_fmac_f32 v24, v93, v69
    ds_read_b128 v[90:93], v98 offset:4608
    v_mfma_f32_16x16x32_bf16 v[74:77], v[34:37], v[58:61], 0
    v_perm_b32 v62, v108, v104, s47
    v_perm_b32 v63, v116, v112, s47
    s_waitcnt lgkmcnt(1)
    v_fmac_f32 v25, v94, v70
    v_fmac_f32 v25, v95, v71
    v_fmac_f32 v25, v96, v72
    v_fmac_f32 v25, v97, v73
    ds_read_b128 v[94:97], v98 offset:4864
    v_mfma_f32_16x16x32_bf16 v[66:69], v[34:37], v[62:65], 0
    v_perm_b32 v58, v109, v105, s46
    v_perm_b32 v59, v117, v113, s46
    s_waitcnt lgkmcnt(1)
    v_fmac_f32 v26, v90, v74
    v_fmac_f32 v26, v91, v75
    v_fmac_f32 v26, v92, v76
    v_fmac_f32 v26, v93, v77
    ds_read_b128 v[90:93], v98 offset:5120
    v_mfma_f32_16x16x32_bf16 v[70:73], v[34:37], v[58:61], 0
    v_perm_b32 v62, v109, v105, s47
    v_perm_b32 v63, v117, v113, s47
    s_waitcnt lgkmcnt(1)
    v_fmac_f32 v27, v94, v66
    v_fmac_f32 v27, v95, v67
    v_fmac_f32 v27, v96, v68
    v_fmac_f32 v27, v97, v69
    ds_read_b128 v[94:97], v98 offset:5376
    v_mfma_f32_16x16x32_bf16 v[74:77], v[34:37], v[62:65], 0
    v_perm_b32 v58, v110, v106, s46
    v_perm_b32 v59, v118, v114, s46
    s_waitcnt lgkmcnt(1)
    v_fmac_f32 v28, v90, v70
    v_fmac_f32 v28, v91, v71
    v_fmac_f32 v28, v92, v72
    v_fmac_f32 v28, v93, v73
    ds_read_b128 v[90:93], v98 offset:5632
    v_mfma_f32_16x16x32_bf16 v[66:69], v[34:37], v[58:61], 0
    v_perm_b32 v62, v110, v106, s47
    v_perm_b32 v63, v118, v114, s47
    s_waitcnt lgkmcnt(1)
    v_fmac_f32 v29, v94, v74
    v_fmac_f32 v29, v95, v75
    v_fmac_f32 v29, v96, v76
    v_fmac_f32 v29, v97, v77
    ds_read_b128 v[94:97], v98 offset:5888
    v_mfma_f32_16x16x32_bf16 v[70:73], v[34:37], v[62:65], 0
    v_perm_b32 v58, v111, v107, s46
    v_perm_b32 v59, v119, v115, s46
    s_waitcnt lgkmcnt(1)
    v_fmac_f32 v30, v90, v66
    v_fmac_f32 v30, v91, v67
    v_fmac_f32 v30, v92, v68
    v_fmac_f32 v30, v93, v69
    ds_read_b128 v[90:93], v98 offset:6144
    v_mfma_f32_16x16x32_bf16 v[74:77], v[34:37], v[58:61], 0
    v_perm_b32 v62, v111, v107, s47
    v_perm_b32 v63, v119, v115, s47
    s_waitcnt lgkmcnt(1)
    v_fmac_f32 v31, v94, v70
    v_fmac_f32 v31, v95, v71
    v_fmac_f32 v31, v96, v72
    v_fmac_f32 v31, v97, v73
    ds_read_b128 v[94:97], v98 offset:6400
    v_mfma_f32_16x16x32_bf16 v[66:69], v[34:37], v[62:65], 0
    s_waitcnt lgkmcnt(1)
    v_fmac_f32 v32, v90, v74
    v_fmac_f32 v32, v91, v75
    v_fmac_f32 v32, v92, v76
    v_fmac_f32 v32, v93, v77
    s_waitcnt lgkmcnt(0)
    s_nop 1
    v_fmac_f32 v33, v94, v66
    v_fmac_f32 v33, v95, v67
    v_fmac_f32 v33, v96, v68
    v_fmac_f32 v33, v97, v69
    s_branch K2_SVADD
K2_V1:
    buffer_load_dwordx4 v[104:107], v50, s[28:31], 0 offen offset:1024 sc1
    buffer_load_dwordx4 v[108:111], v51, s[28:31], 0 offen offset:1024 sc1
    buffer_load_dwordx4 v[112:115], v50, s[28:31], 0 offen offset:0 sc1
    buffer_load_dwordx4 v[116:119], v51, s[28:31], 0 offen offset:0 sc1
    buffer_load_dwordx4 v[120:123], v50, s[28:31], 0 offen offset:256 sc1
    buffer_load_dwordx4 v[124:127], v51, s[28:31], 0 offen offset:256 sc1
    buffer_load_dwordx4 v[128:131], v50, s[28:31], 0 offen offset:512 sc1
    buffer_load_dwordx4 v[132:135], v51, s[28:31], 0 offen offset:512 sc1
    buffer_load_dwordx4 v[136:139], v50, s[28:31], 0 offen offset:768 sc1
    buffer_load_dwordx4 v[140:143], v51, s[28:31], 0 offen offset:768 sc1
    s_cmp_lg_u32 s57, 0
    s_cbranch_scc1 K2_V1_GO
    s_waitcnt vmcnt(10)
    v_lshlrev_b32 v2, 16, v18
    v_and_b32 v3, 0xffff0000, v18
    v_lshlrev_b32 v4, 16, v19
    v_and_b32 v5, 0xffff0000, v19
    v_lshlrev_b32 v6, 16, v20
    v_and_b32 v7, 0xffff0000, v20
    v_lshlrev_b32 v8, 16, v21
    v_and_b32 v9, 0xffff0000, v21
    v_lshlrev_b32 v10, 16, v22
    v_and_b32 v11, 0xffff0000, v22
    v_lshlrev_b32 v12, 16, v23
    v_and_b32 v13, 0xffff0000, v23
    v_lshlrev_b32 v14, 16, v24
    v_and_b32 v15, 0xffff0000, v24
    v_lshlrev_b32 v16, 16, v25
    v_and_b32 v17, 0xffff0000, v25
    v_lshlrev_b32 v18, 16, v26
    v_and_b32 v19, 0xffff0000, v26
    v_lshlrev_b32 v20, 16, v27
    v_and_b32 v21, 0xffff0000, v27
    v_lshlrev_b32 v22, 16, v28
    v_and_b32 v23, 0xffff0000, v28
    v_lshlrev_b32 v24, 16, v29
    v_and_b32 v25, 0xffff0000, v29
    v_lshlrev_b32 v26, 16, v30
    v_and_b32 v27, 0xffff0000, v30
    v_lshlrev_b32 v28, 16, v31
    v_and_b32 v29, 0xffff0000, v31
    v_lshlrev_b32 v30, 16, v32
    v_and_b32 v31, 0xffff0000, v32
    v_lshlrev_b32 v32, 16, v33
    v_and_b32 v33, 0xffff0000, v33
    s_mov_b32 s57, 1
K2_V1_GO:
    ds_read_b128 v[90:93], v98 offset:6656
    ds_read_b128 v[94:97], v98 offset:6912
    s_waitcnt vmcnt(8)
    v_perm_b32 v58, v108, v104, s46
    s_waitcnt lgkmcnt(2)
    s_nop 0
    v_mfma_f32_16x16x32_bf16 v[66:69], v[38:41], v[58:61], 0
    v_mfma_f32_16x16x32_bf16 v[70:73], v[42:45], v[58:61], 0
    v_mfma_f32_16x16x32_bf16 v[74:77], v[46:49], v[58:61], 0
    v_perm_b32 v62, v108, v104, s47
    s_nop 1
    v_mfma_f32_16x16x32_bf16 v[78:81], v[38:41], v[62:65], 0
    v_mfma_f32_16x16x32_bf16 v[82:85], v[42:45], v[62:65], 0
    v_mfma_f32_16x16x32_bf16 v[86:89], v[46:49], v[62:65], 0
    v_perm_b32 v58, v109, v105, s46
    s_waitcnt lgkmcnt(1)
    v_fmac_f32 v10, v90, v66
    v_fmac_f32 v18, v90, v70
    v_fmac_f32 v26, v90, v74
    v_fmac_f32 v10, v91, v67
    v_fmac_f32 v18, v91, v71
    v_fmac_f32 v26, v91, v75
    v_fmac_f32 v10, v92, v68
    v_fmac_f32 v18, v92, v72
    v_fmac_f32 v26, v92, v76
    v_fmac_f32 v10, v93, v69
    v_fmac_f32 v18, v93, v73
    v_fmac_f32 v26, v93, v77
    ds_read_b128 v[90:93], v98 offset:7168
    v_mfma_f32_16x16x32_bf16 v[66:69], v[38:41], v[58:61], 0
    v_mfma_f32_16x16x32_bf16 v[70:73], v[42:45], v[58:61], 0
    v_mfma_f32_16x16x32_bf16 v[74:77], v[46:49], v[58:61], 0
    v_perm_b32 v62, v109, v105, s47
    s_waitcnt lgkmcnt(1)
    v_fmac_f32 v11, v94, v78
    v_fmac_f32 v19, v94, v82
    v_fmac_f32 v27, v94, v86
    v_fmac_f32 v11, v95, v79
    v_fmac_f32 v19, v95, v83
    v_fmac_f32 v27, v95, v87
    v_fmac_f32 v11, v96, v80
    v_fmac_f32 v19, v96, v84
    v_fmac_f32 v27, v96, v88
    v_fmac_f32 v11, v97, v81
    v_fmac_f32 v19, v97, v85
    v_fmac_f32 v27, v97, v89
    ds_read_b128 v[94:97], v98 offset:7424
    v_mfma_f32_16x16x32_bf16 v[78:81], v[38:41], v[62:65], 0
    v_mfma_f32_16x16x32_bf16 v[82:85], v[42:45], v[62:65], 0
    v_mfma_f32_16x16x32_bf16 v[86:89], v[46:49], v[62:65], 0
    v_perm_b32 v58, v110, v106, s46
    s_waitcnt lgkmcnt(1)
    v_fmac_f32 v12, v90, v66
    v_fmac_f32 v20, v90, v70
    v_fmac_f32 v28, v90, v74
    v_fmac_f32 v12, v91, v67
    v_fmac_f32 v20, v91, v71
    v_fmac_f32 v28, v91, v75
    v_fmac_f32 v12, v92, v68
    v_fmac_f32 v20, v92, v72
    v_fmac_f32 v28, v92, v76
    v_fmac_f32 v12, v93, v69
    v_fmac_f32 v20, v93, v73
    v_fmac_f32 v28, v93, v77
    ds_read_b128 v[90:93], v98 offset:7680
    v_mfma_f32_16x16x32_bf16 v[66:69], v[38:41], v[58:61], 0
    v_mfma_f32_16x16x32_bf16 v[70:73], v[42:45], v[58:61], 0
    v_mfma_f32_16x16x32_bf16 v[74:77], v[46:49], v[58:61], 0
    v_perm_b32 v62, v110, v106, s47
    s_waitcnt lgkmcnt(1)
    v_fmac_f32 v13, v94, v78
    v_fmac_f32 v21, v94, v82
    v_fmac_f32 v29, v94, v86
    v_fmac_f32 v13, v95, v79
    v_fmac_f32 v21, v95, v83
    v_fmac_f32 v29, v95, v87
    v_fmac_f32 v13, v96, v80
    v_fmac_f32 v21, v96, v84
    v_fmac_f32 v29, v96, v88
    v_fmac_f32 v13, v97, v81
    v_fmac_f32 v21, v97, v85
    v_fmac_f32 v29, v97, v89
    ds_read_b128 v[94:97], v98 offset:7936
    v_mfma_f32_16x16x32_bf16 v[78:81], v[38:41], v[62:65], 0
    v_mfma_f32_16x16x32_bf16 v[82:85], v[42:45], v[62:65], 0
    v_mfma_f32_16x16x32_bf16 v[86:89], v[46:49], v[62:65], 0
    v_perm_b32 v58, v111, v107, s46
    s_waitcnt lgkmcnt(1)
    v_fmac_f32 v14, v90, v66
    v_fmac_f32 v22, v90, v70
    v_fmac_f32 v30, v90, v74
    v_fmac_f32 v14, v91, v67
    v_fmac_f32 v22, v91, v71
    v_fmac_f32 v30, v91, v75
    v_fmac_f32 v14, v92, v68
    v_fmac_f32 v22, v92, v72
    v_fmac_f32 v30, v92, v76
    v_fmac_f32 v14, v93, v69
    v_fmac_f32 v22, v93, v73
    v_fmac_f32 v30, v93, v77
    ds_read_b128 v[90:93], v98 offset:8192
    v_mfma_f32_16x16x32_bf16 v[66:69], v[38:41], v[58:61], 0
    v_mfma_f32_16x16x32_bf16 v[70:73], v[42:45], v[58:61], 0
    v_mfma_f32_16x16x32_bf16 v[74:77], v[46:49], v[58:61], 0
    v_perm_b32 v62, v111, v107, s47
    s_waitcnt lgkmcnt(1)
    v_fmac_f32 v15, v94, v78
    v_fmac_f32 v23, v94, v82
    v_fmac_f32 v31, v94, v86
    v_fmac_f32 v15, v95, v79
    v_fmac_f32 v23, v95, v83
    v_fmac_f32 v31, v95, v87
    v_fmac_f32 v15, v96, v80
    v_fmac_f32 v23, v96, v84
    v_fmac_f32 v31, v96, v88
    v_fmac_f32 v15, v97, v81
    v_fmac_f32 v23, v97, v85
    v_fmac_f32 v31, v97, v89
    ds_read_b128 v[94:97], v98 offset:8448
    v_mfma_f32_16x16x32_bf16 v[78:81], v[38:41], v[62:65], 0
    v_mfma_f32_16x16x32_bf16 v[82:85], v[42:45], v[62:65], 0
    v_mfma_f32_16x16x32_bf16 v[86:89], v[46:49], v[62:65], 0
    s_waitcnt vmcnt(6)
    v_perm_b32 v58, v116, v112, s46
    s_waitcnt lgkmcnt(1)
    v_fmac_f32 v16, v90, v66
    v_fmac_f32 v24, v90, v70
    v_fmac_f32 v32, v90, v74
    v_fmac_f32 v16, v91, v67
    v_fmac_f32 v24, v91, v71
    v_fmac_f32 v32, v91, v75
    v_fmac_f32 v16, v92, v68
    v_fmac_f32 v24, v92, v72
    v_fmac_f32 v32, v92, v76
    v_fmac_f32 v16, v93, v69
    v_fmac_f32 v24, v93, v73
    v_fmac_f32 v32, v93, v77
    ds_read_b128 v[90:93], v98 offset:2560
    v_mfma_f32_16x16x32_bf16 v[74:77], v[34:37], v[58:61], 0
    v_perm_b32 v62, v116, v112, s47
    s_waitcnt lgkmcnt(1)
    v_fmac_f32 v17, v94, v78
    v_fmac_f32 v25, v94, v82
    v_fmac_f32 v33, v94, v86
    v_fmac_f32 v17, v95, v79
    v_fmac_f32 v25, v95, v83
    v_fmac_f32 v33, v95, v87
    v_fmac_f32 v17, v96, v80
    v_fmac_f32 v25, v96, v84
    v_fmac_f32 v33, v96, v88
    v_fmac_f32 v17, v97, v81
    v_fmac_f32 v25, v97, v85
    v_fmac_f32 v33, v97, v89
    ds_read_b128 v[94:97], v98 offset:2816
    v_mfma_f32_16x16x32_bf16 v[66:69], v[34:37], v[62:65], 0
    v_perm_b32 v58, v117, v113, s46
    s_waitcnt lgkmcnt(1)
    v_fmac_f32 v2, v90, v74
    v_fmac_f32 v2, v91, v75
    v_fmac_f32 v2, v92, v76
    v_fmac_f32 v2, v93, v77
    ds_read_b128 v[90:93], v98 offset:3072
    v_mfma_f32_16x16x32_bf16 v[70:73], v[34:37], v[58:61], 0
    v_perm_b32 v62, v117, v113, s47
    s_waitcnt lgkmcnt(1)
    v_fmac_f32 v3, v94, v66
    v_fmac_f32 v3, v95, v67
    v_fmac_f32 v3, v96, v68
    v_fmac_f32 v3, v97, v69
    ds_read_b128 v[94:97], v98 offset:3328
    v_mfma_f32_16x16x32_bf16 v[74:77], v[34:37], v[62:65], 0
    v_perm_b32 v58, v118, v114, s46
    s_waitcnt lgkmcnt(1)
    v_fmac_f32 v4, v90, v70
    v_fmac_f32 v4, v91, v71
    v_fmac_f32 v4, v92, v72
    v_fmac_f32 v4, v93, v73
    ds_read_b128 v[90:93], v98 offset:3584
    v_mfma_f32_16x16x32_bf16 v[66:69], v[34:37], v[58:61], 0
    v_perm_b32 v62, v118, v114, s47
    s_waitcnt lgkmcnt(1)
    v_fmac_f32 v5, v94, v74
    v_fmac_f32 v5, v95, v75
    v_fmac_f32 v5, v96, v76
    v_fmac_f32 v5, v97, v77
    ds_read_b128 v[94:97], v98 offset:3840
    v_mfma_f32_16x16x32_bf16 v[70:73], v[34:37], v[62:65], 0
    v_perm_b32 v58, v119, v115, s46
    s_waitcnt lgkmcnt(1)
    v_fmac_f32 v6, v90, v66
    v_fmac_f32 v6, v91, v67
    v_fmac_f32 v6, v92, v68
    v_fmac_f32 v6, v93, v69
    ds_read_b128 v[90:93], v98 offset:4096
    v_mfma_f32_16x16x32_bf16 v[74:77], v[34:37], v[58:61], 0
    v_perm_b32 v62, v119, v115, s47
    s_waitcnt lgkmcnt(1)
    v_fmac_f32 v7, v94, v70
    v_fmac_f32 v7, v95, v71
    v_fmac_f32 v7, v96, v72
    v_fmac_f32 v7, v97, v73
    ds_read_b128 v[94:97], v98 offset:4352
    v_mfma_f32_16x16x32_bf16 v[66:69], v[34:37], v[62:65], 0
    s_waitcnt vmcnt(4)
    v_perm_b32 v58, v124, v120, s46
    s_waitcnt lgkmcnt(1)
    v_fmac_f32 v8, v90, v74
    v_fmac_f32 v8, v91, v75
    v_fmac_f32 v8, v92, v76
    v_fmac_f32 v8, v93, v77
    ds_read_b128 v[90:93], v98 offset:4608
    v_mfma_f32_16x16x32_bf16 v[70:73], v[34:37], v[58:61], 0
    v_perm_b32 v62, v124, v120, s47
    s_waitcnt lgkmcnt(1)
    v_fmac_f32 v9, v94, v66
    v_fmac_f32 v9, v95, v67
    v_fmac_f32 v9, v96, v68
    v_fmac_f32 v9, v97, v69
    ds_read_b128 v[94:97], v98 offset:4864
    v_mfma_f32_16x16x32_bf16 v[74:77], v[34:37], v[62:65], 0
    v_perm_b32 v58, v125, v121, s46
    s_waitcnt lgkmcnt(1)
    v_fmac_f32 v10, v90, v70
    v_fmac_f32 v10, v91, v71
    v_fmac_f32 v10, v92, v72
    v_fmac_f32 v10, v93, v73
    ds_read_b128 v[90:93], v98 offset:5120
    v_mfma_f32_16x16x32_bf16 v[66:69], v[34:37], v[58:61], 0
    v_perm_b32 v62, v125, v121, s47
    s_waitcnt lgkmcnt(1)
    v_fmac_f32 v11, v94, v74
    v_fmac_f32 v11, v95, v75
    v_fmac_f32 v11, v96, v76
    v_fmac_f32 v11, v97, v77
    ds_read_b128 v[94:97], v98 offset:5376
    v_mfma_f32_16x16x32_bf16 v[70:73], v[34:37], v[62:65], 0
    v_perm_b32 v58, v126, v122, s46
    s_waitcnt lgkmcnt(1)
    v_fmac_f32 v12, v90, v66
    v_fmac_f32 v12, v91, v67
    v_fmac_f32 v12, v92, v68
    v_fmac_f32 v12, v93, v69
    ds_read_b128 v[90:93], v98 offset:5632
    v_mfma_f32_16x16x32_bf16 v[74:77], v[34:37], v[58:61], 0
    v_perm_b32 v62, v126, v122, s47
    s_waitcnt lgkmcnt(1)
    v_fmac_f32 v13, v94, v70
    v_fmac_f32 v13, v95, v71
    v_fmac_f32 v13, v96, v72
    v_fmac_f32 v13, v97, v73
    ds_read_b128 v[94:97], v98 offset:5888
    v_mfma_f32_16x16x32_bf16 v[66:69], v[34:37], v[62:65], 0
    v_perm_b32 v58, v127, v123, s46
    s_waitcnt lgkmcnt(1)
    v_fmac_f32 v14, v90, v74
    v_fmac_f32 v14, v91, v75
    v_fmac_f32 v14, v92, v76
    v_fmac_f32 v14, v93, v77
    ds_read_b128 v[90:93], v98 offset:6144
    v_mfma_f32_16x16x32_bf16 v[70:73], v[34:37], v[58:61], 0
    v_perm_b32 v62, v127, v123, s47
    s_waitcnt lgkmcnt(1)
    v_fmac_f32 v15, v94, v66
    v_fmac_f32 v15, v95, v67
    v_fmac_f32 v15, v96, v68
    v_fmac_f32 v15, v97, v69
    ds_read_b128 v[94:97], v98 offset:6400
    v_mfma_f32_16x16x32_bf16 v[74:77], v[34:37], v[62:65], 0
    s_waitcnt vmcnt(2)
    v_perm_b32 v58, v132, v128, s46
    s_waitcnt lgkmcnt(1)
    v_fmac_f32 v16, v90, v70
    v_fmac_f32 v16, v91, v71
    v_fmac_f32 v16, v92, v72
    v_fmac_f32 v16, v93, v73
    ds_read_b128 v[90:93], v98 offset:4608
    v_mfma_f32_16x16x32_bf16 v[66:69], v[34:37], v[58:61], 0
    v_perm_b32 v62, v132, v128, s47
    s_waitcnt lgkmcnt(1)
    v_fmac_f32 v17, v94, v74
    v_fmac_f32 v17, v95, v75
    v_fmac_f32 v17, v96, v76
    v_fmac_f32 v17, v97, v77
    ds_read_b128 v[94:97], v98 offset:4864
    v_mfma_f32_16x16x32_bf16 v[70:73], v[34:37], v[62:65], 0
    v_perm_b32 v58, v133, v129, s46
    s_waitcnt lgkmcnt(1)
    v_fmac_f32 v18, v90, v66
    v_fmac_f32 v18, v91, v67
    v_fmac_f32 v18, v92, v68
    v_fmac_f32 v18, v93, v69
    ds_read_b128 v[90:93], v98 offset:5120
    v_mfma_f32_16x16x32_bf16 v[74:77], v[34:37], v[58:61], 0
    v_perm_b32 v62, v133, v129, s47
    s_waitcnt lgkmcnt(1)
    v_fmac_f32 v19, v94, v70
    v_fmac_f32 v19, v95, v71
    v_fmac_f32 v19, v96, v72
    v_fmac_f32 v19, v97, v73
    ds_read_b128 v[94:97], v98 offset:5376
    v_mfma_f32_16x16x32_bf16 v[66:69], v[34:37], v[62:65], 0
    v_perm_b32 v58, v134, v130, s46
    s_waitcnt lgkmcnt(1)
    v_fmac_f32 v20, v90, v74
    v_fmac_f32 v20, v91, v75
    v_fmac_f32 v20, v92, v76
    v_fmac_f32 v20, v93, v77
    ds_read_b128 v[90:93], v98 offset:5632
    v_mfma_f32_16x16x32_bf16 v[70:73], v[34:37], v[58:61], 0
    v_perm_b32 v62, v134, v130, s47
    s_waitcnt lgkmcnt(1)
    v_fmac_f32 v21, v94, v66
    v_fmac_f32 v21, v95, v67
    v_fmac_f32 v21, v96, v68
    v_fmac_f32 v21, v97, v69
    ds_read_b128 v[94:97], v98 offset:5888
    v_mfma_f32_16x16x32_bf16 v[74:77], v[34:37], v[62:65], 0
    v_perm_b32 v58, v135, v131, s46
    s_waitcnt lgkmcnt(1)
    v_fmac_f32 v22, v90, v70
    v_fmac_f32 v22, v91, v71
    v_fmac_f32 v22, v92, v72
    v_fmac_f32 v22, v93, v73
    ds_read_b128 v[90:93], v98 offset:6144
    v_mfma_f32_16x16x32_bf16 v[66:69], v[34:37], v[58:61], 0
    v_perm_b32 v62, v135, v131, s47
    s_waitcnt lgkmcnt(1)
    v_fmac_f32 v23, v94, v74
    v_fmac_f32 v23, v95, v75
    v_fmac_f32 v23, v96, v76
    v_fmac_f32 v23, v97, v77
    ds_read_b128 v[94:97], v98 offset:6400
    v_mfma_f32_16x16x32_bf16 v[70:73], v[34:37], v[62:65], 0
    s_waitcnt vmcnt(0)
    v_perm_b32 v58, v140, v136, s46
    s_waitcnt lgkmcnt(1)
    v_fmac_f32 v24, v90, v66
    v_fmac_f32 v24, v91, v67
    v_fmac_f32 v24, v92, v68
    v_fmac_f32 v24, v93, v69
    ds_read_b128 v[90:93], v98 offset:4608
    v_mfma_f32_16x16x32_bf16 v[74:77], v[34:37], v[58:61], 0
    v_perm_b32 v62, v140, v136, s47
    s_waitcnt lgkmcnt(1)
    v_fmac_f32 v25, v94, v70
    v_fmac_f32 v25, v95, v71
    v_fmac_f32 v25, v96, v72
    v_fmac_f32 v25, v97, v73
    ds_read_b128 v[94:97], v98 offset:4864
    v_mfma_f32_16x16x32_bf16 v[66:69], v[34:37], v[62:65], 0
    v_perm_b32 v58, v141, v137, s46
    s_waitcnt lgkmcnt(1)
    v_fmac_f32 v26, v90, v74
    v_fmac_f32 v26, v91, v75
    v_fmac_f32 v26, v92, v76
    v_fmac_f32 v26, v93, v77
    ds_read_b128 v[90:93], v98 offset:5120
    v_mfma_f32_16x16x32_bf16 v[70:73], v[34:37], v[58:61], 0
    v_perm_b32 v62, v141, v137, s47
    s_waitcnt lgkmcnt(1)
    v_fmac_f32 v27, v94, v66
    v_fmac_f32 v27, v95, v67
    v_fmac_f32 v27, v96, v68
    v_fmac_f32 v27, v97, v69
    ds_read_b128 v[94:97], v98 offset:5376
    v_mfma_f32_16x16x32_bf16 v[74:77], v[34:37], v[62:65], 0
    v_perm_b32 v58, v142, v138, s46
    s_waitcnt lgkmcnt(1)
    v_fmac_f32 v28, v90, v70
    v_fmac_f32 v28, v91, v71
    v_fmac_f32 v28, v92, v72
    v_fmac_f32 v28, v93, v73
    ds_read_b128 v[90:93], v98 offset:5632
    v_mfma_f32_16x16x32_bf16 v[66:69], v[34:37], v[58:61], 0
    v_perm_b32 v62, v142, v138, s47
    s_waitcnt lgkmcnt(1)
    v_fmac_f32 v29, v94, v74
    v_fmac_f32 v29, v95, v75
    v_fmac_f32 v29, v96, v76
    v_fmac_f32 v29, v97, v77
    ds_read_b128 v[94:97], v98 offset:5888
    v_mfma_f32_16x16x32_bf16 v[70:73], v[34:37], v[62:65], 0
    v_perm_b32 v58, v143, v139, s46
    s_waitcnt lgkmcnt(1)
    v_fmac_f32 v30, v90, v66
    v_fmac_f32 v30, v91, v67
    v_fmac_f32 v30, v92, v68
    v_fmac_f32 v30, v93, v69
    ds_read_b128 v[90:93], v98 offset:6144
    v_mfma_f32_16x16x32_bf16 v[74:77], v[34:37], v[58:61], 0
    v_perm_b32 v62, v143, v139, s47
    s_waitcnt lgkmcnt(1)
    v_fmac_f32 v31, v94, v70
    v_fmac_f32 v31, v95, v71
    v_fmac_f32 v31, v96, v72
    v_fmac_f32 v31, v97, v73
    ds_read_b128 v[94:97], v98 offset:6400
    v_mfma_f32_16x16x32_bf16 v[66:69], v[34:37], v[62:65], 0
    s_waitcnt lgkmcnt(1)
    v_fmac_f32 v32, v90, v74
    v_fmac_f32 v32, v91, v75
    v_fmac_f32 v32, v92, v76
    v_fmac_f32 v32, v93, v77
    s_waitcnt lgkmcnt(0)
    s_nop 1
    v_fmac_f32 v33, v94, v66
    v_fmac_f32 v33, v95, v67
    v_fmac_f32 v33, v96, v68
    v_fmac_f32 v33, v97, v69
    s_nop 0
K2_SVADD:
K2_KDONE:
    s_cmp_eq_u32 s55, 0
    s_cbranch_scc1 K2_OUT
    s_waitcnt vmcnt(0) lgkmcnt(0)
    s_barrier
    v_mov_b32 v50, 0
    v_mov_b32 v51, 0
    v_mov_b32 v52, 0
    v_mov_b32 v53, 0
    v_lshlrev_b32 v54, 4, v0
    v_add_u32 v57, 40960, v54
    v_lshlrev_b32 v55, 2, v0
    v_mov_b32 v56, s48
    v_mov_b32 v60, 1
    ds_write_b128 v54, v[50:53] offset:8768
    ds_write_b128 v54, v[50:53] offset:19008
    ds_write_b128 v54, v[50:53] offset:29248
    ds_write_b128 v54, v[50:53] offset:39488
    ds_write_b128 v57, v[50:53] offset:8768
    ds_write_b128 v57, v[50:53] offset:19008
    ds_write_b128 v57, v[50:53] offset:29248
    ds_write_b128 v57, v[50:53] offset:39488
    ds_write_b32 v55, v56 offset:0
    ds_write_b128 v50, v[50:53] offset:8704
    ds_write_b128 v50, v[50:53] offset:8720
    ds_write_b128 v50, v[50:53] offset:8736
    s_waitcnt lgkmcnt(0)
    s_barrier
    s_branch K2_SLOW
K2_OUT:
    s_cmp_lg_u32 s57, 0
    s_cbranch_scc1 K2_PACK
    s_waitcnt vmcnt(0)
    buffer_store_dwordx4 v[18:21], v99, s[24:27], 0 offen offset:0 sc1
    s_waitcnt vmcnt(0)
    buffer_store_dwordx4 v[22:25], v99, s[24:27], 0 offen offset:256 sc1
    s_waitcnt vmcnt(0)
    buffer_store_dwordx4 v[26:29], v99, s[24:27], 0 offen offset:512 sc1
    s_waitcnt vmcnt(0)
    buffer_store_dwordx4 v[30:33], v99, s[24:27], 0 offen offset:768 sc1
    s_branch K2_FIN
K2_PACK:
    v_cvt_pk_bf16_f32 v104, v2, v3
    v_cvt_pk_bf16_f32 v105, v4, v5
    v_cvt_pk_bf16_f32 v106, v6, v7
    v_cvt_pk_bf16_f32 v107, v8, v9
    buffer_store_dwordx4 v[104:107], v99, s[24:27], 0 offen offset:0 sc1
    v_cvt_pk_bf16_f32 v108, v10, v11
    v_cvt_pk_bf16_f32 v109, v12, v13
    v_cvt_pk_bf16_f32 v110, v14, v15
    v_cvt_pk_bf16_f32 v111, v16, v17
    buffer_store_dwordx4 v[108:111], v99, s[24:27], 0 offen offset:256 sc1
    v_cvt_pk_bf16_f32 v112, v18, v19
    v_cvt_pk_bf16_f32 v113, v20, v21
    v_cvt_pk_bf16_f32 v114, v22, v23
    v_cvt_pk_bf16_f32 v115, v24, v25
    buffer_store_dwordx4 v[112:115], v99, s[24:27], 0 offen offset:512 sc1
    v_cvt_pk_bf16_f32 v116, v26, v27
    v_cvt_pk_bf16_f32 v117, v28, v29
    v_cvt_pk_bf16_f32 v118, v30, v31
    v_cvt_pk_bf16_f32 v119, v32, v33
    buffer_store_dwordx4 v[116:119], v99, s[24:27], 0 offen offset:768 sc1
K2_FIN:
K_END:
    s_endpgm
.section .rodata,"a"
.p2align 6
.amdhsa_kernel standalone__molecular_angular_painn__graph_kernel
  .amdhsa_next_free_vgpr 168
  .amdhsa_next_free_sgpr 102
  .amdhsa_accum_offset 168
  .amdhsa_group_segment_fixed_size 0
  .amdhsa_kernarg_size 88
  .amdhsa_user_sgpr_count 2
  .amdhsa_user_sgpr_kernarg_segment_ptr 1
  .amdhsa_system_sgpr_workgroup_id_x 1
  .amdhsa_float_denorm_mode_32 3
.end_amdhsa_kernel
```
